```python
import torch

def _softmax(x, axis=-1):
    return torch.softmax(x, dim=axis)
def _gelu(x):
    return torch.nn.functional.gelu(x, approximate="tanh")
def _silu(x):
    return torch.nn.functional.silu(x)
def _sigmoid(x):
    return torch.sigmoid(x)
def _layernorm(x, axis=-1, eps=1e-5):
    m = x.mean(dim=axis, keepdim=True)
    v = x.var(dim=axis, keepdim=True, unbiased=False)
    return (x - m) / torch.sqrt(v + eps)
def _scatter_add(tgt, idx, src, axis=0):
    return tgt.clone().index_add_(axis, idx, src)
def _segment_sum(src, seg, n):
    out = torch.zeros((n,) + src.shape[1:], dtype=src.dtype)
    return out.index_add_(0, seg, src)
def _pad(x, pw):
    flat = tuple(v for pair in reversed(pw) for v in pair)
    return torch.nn.functional.pad(x, flat)

kernel_name = 'recurrent_scan__sliding_block_cached__moe_arch_mod__prompt'

def setup_inputs():

    _w = (lambda a: (lambda t: t.to(torch.bfloat16) if t.is_floating_point() else t)(torch.as_tensor(a)))
    def _A_setup():
        B, Sq, D = 1, 2048, 1024
        Hq, Hkv, Sk, Dh = 32, 4, 2048, 128
        assert Hq % Hkv == 0, (Hq, Hkv)
        return {
            "x": _w((lambda *s: torch.randn(*s, dtype=torch.bfloat16) * 0.05)(B, Sq, D)),
            "k_cache": _w((lambda *s: torch.randn(*s, dtype=torch.bfloat16) * 0.8)(B, Hkv, Sk, Dh)),
            "v_cache": _w((lambda *s: torch.randn(*s, dtype=torch.bfloat16) * 0.2)(B, Hkv, Sk, Dh)),
            "wq": _w((lambda *s: torch.randn(*s, dtype=torch.bfloat16) * 0.8)(D, Hq * Dh) * (D ** -0.5)),
            "wo": _w((lambda *s: torch.randn(*s, dtype=torch.bfloat16) * 0.2)(Hq * Dh, D) * ((Hq * Dh) ** -0.5)),
        }
    _A_in = _A_setup()

    def _B_setup():
        B, S, D, F, C = 1, 2048, 1024, 3584, 1
        return {
            "x": _w((lambda *s: torch.randn(*s, dtype=torch.bfloat16) * 0.05)(B, S, D)),
            "w_r": _w((lambda *s: torch.randn(*s, dtype=torch.bfloat16) * 0.2)(D)),
            "w_gate": _w((lambda *s: torch.randn(*s, dtype=torch.bfloat16) * 0.1)(D, F)),
            "w_up": _w((lambda *s: torch.randn(*s, dtype=torch.bfloat16) * 0.1)(D, F)),
            "w_down": _w((lambda *s: torch.randn(*s, dtype=torch.bfloat16) * 0.1)(F, D)),
        }
    _B_in = _B_setup()

    return {
        "A_x": _A_in["x"],
        "A_k_cache": _A_in["k_cache"],
        "A_v_cache": _A_in["v_cache"],
        "A_wq": _A_in["wq"],
        "A_wo": _A_in["wo"],
        "B_x": _B_in["x"],
        "B_w_r": _B_in["w_r"],
        "B_w_gate": _B_in["w_gate"],
        "B_w_up": _B_in["w_up"],
        "B_w_down": _B_in["w_down"],
    }

def reference(A_x, A_k_cache, A_v_cache, A_wq, A_wo, B_x, B_w_r, B_w_gate, B_w_up, B_w_down):
    def _A_ref(x, k_cache, v_cache, wq, wo):
        B, Sq, D = x.shape
        Hq, Dh = 32, 128
        Hkv, Sk = k_cache.shape[1], k_cache.shape[2]
        W = min(4096, max(256, Sk // 4))
        rep = Hq // Hkv
        q = (lambda x, *d: x.permute(*d))((x @ wq).reshape(B, Sq, Hq, Dh), 0, 2, 1, 3)
        k = (lambda x, n, axis: torch.repeat_interleave(x, n, dim=axis))(k_cache[:, :, Sk - W:, :], rep, axis=1)
        v = (lambda x, n, axis: torch.repeat_interleave(x, n, dim=axis))(v_cache[:, :, Sk - W:, :], rep, axis=1)
        scores = torch.einsum("bhqd,bhkd->bhqk", q, k) * (Dh ** -0.5)
        p = _softmax(scores, axis=-1)
        o = torch.einsum("bhqk,bhkd->bhqd", p, v)
        return (lambda x, *d: x.permute(*d))(o, 0, 2, 1, 3).reshape(B, Sq, Hq * Dh) @ wo

    def _B_ref(x, w_r, w_gate, w_up, w_down):
        B, S, D = x.shape
        C = 1
        r = x @ w_r
        idx = torch.argsort(-r, axis=-1)[:, :C]
        idx_e = (lambda x, n, axis: torch.repeat_interleave(x, n, dim=axis))(idx.reshape(B, C, 1), D, axis=2)
        x_sel = (lambda x, i, axis: torch.take_along_dim(x, i, dim=axis))(x, idx_e, axis=1)
        g = _silu(x_sel @ w_gate)
        u = x_sel @ w_up
        y = (g * u) @ w_down
        r_sel = _sigmoid((lambda x, i, axis: torch.take_along_dim(x, i, dim=axis))(r, idx, axis=1))
        y = y * r_sel.reshape(B, C, 1)
        b_off = (torch.arange(B) * S).reshape(B, 1)
        flat_idx = (idx + b_off).reshape(B * C)
        zero = (x * 0.0).reshape(B * S, D)
        upd = _scatter_add(zero, flat_idx, y.reshape(B * C, D), axis=0)
        return x + upd.reshape(B, S, D)

    x = A_x
    xn = _layernorm(x, axis=-1)
    s = _A_ref(xn, A_k_cache, A_v_cache, A_wq, A_wo)
    g = _silu(_B_ref(xn, B_w_r, B_w_gate, B_w_up, B_w_down))
    return x + s * g
```

```asm
; @launch grid=(256,1,1) block=(512,1,1) lds=163840
.amdgcn_target "amdgcn-amd-amdhsa--gfx950"
.text
.globl recurrent_scan__sliding_block_cached__moe_arch_mod__prompt_kernel
.p2align 8
.type recurrent_scan__sliding_block_cached__moe_arch_mod__prompt_kernel,@function
recurrent_scan__sliding_block_cached__moe_arch_mod__prompt_kernel:
    s_cmp_ge_u32 s2, 256
    s_cbranch_scc1 K2_END
    s_load_dwordx2 s[74:75], s[0:1], 0
    s_load_dwordx2 s[76:77], s[0:1], 48
    s_load_dwordx4 s[8:11], s[0:1], 24
    s_load_dwordx2 s[18:19], s[0:1], 96
    s_load_dwordx4 s[4:7], s[0:1], 8
    s_load_dwordx4 s[12:15], s[0:1], 56
    s_load_dwordx2 s[16:17], s[0:1], 72
    s_load_dwordx2 s[78:79], s[0:1], 80
    s_load_dwordx2 s[66:67], s[0:1], 88
    s_setprio 3
    v_lshrrev_b32 v14, 6, v0
    v_and_b32 v1, 63, v0
    v_readfirstlane_b32 s3, v14
    s_and_b32 s60, s2, 7
    s_lshr_b32 s61, s2, 3
    s_lshr_b32 s22, s60, 1
    s_and_b32 s60, s60, 1
    s_lshl_b32 s60, s60, 2
    s_lshr_b32 s62, s61, 3
    s_add_u32 s21, s60, s62
    s_and_b32 s61, s61, 7
    s_lshl_b32 s20, s22, 3
    s_add_u32 s20, s20, s61
    s_lshl_b32 s65, s21, 5
    s_add_u32 s65, s65, s20
    v_lshrrev_b32 v12, 4, v1
    v_and_b32 v13, 3, v1
    v_lshlrev_b32 v13, 4, v13
    v_lshl_add_u32 v13, v12, 6, v13
    v_bfe_u32 v15, v1, 2, 2
    v_lshl_add_u32 v246, v15, 13, v13
    v_and_b32 v247, 1, v14
    v_lshlrev_b32 v247, 5, v247
    v_xor_b32 v246, v246, v247
    v_add_u32 v247, 31744, v246
    v_lshrrev_b32 v249, 3, v1
    v_and_b32 v80, 7, v1
    v_xor_b32 v80, v80, v12
    v_lshlrev_b32 v80, 4, v80
    v_lshl_add_u32 v80, v249, 11, v80
    v_xor_b32 v81, 64, v80
    v_add_u32 v81, 15360, v81
    v_add_u32 v82, 30720, v80
    v_add_u32 v83, 30720, v81
    s_lshl_b32 s100, s3, 12
    s_add_u32 s100, s100, 65536
    s_lshl_b32 s24, s3, 16
    s_lshl_b32 s25, s3, 11
    s_mov_b32 s26, 0
    s_lshl_b32 s60, s20, 8
    s_lshl_b32 s61, s21, 3
    s_add_u32 s61, s61, s3
    s_lshl_b32 s61, s61, 16
    s_mov_b32 s39, 0x20000
    s_sub_u32 s38, 0x800000, s60
    s_mov_b32 s42, 0x10000
    s_mov_b32 s43, 0x20000
    v_lshlrev_b32 v210, 4, v1
    v_lshl_add_u32 v90, v14, 11, v210
    s_lshl_b32 s62, s65, 14
    v_add_u32 v90, s62, v90
    s_memrealtime s[62:63]
    s_waitcnt lgkmcnt(0)
    s_add_u32 s36, s8, s60
    s_addc_u32 s37, s9, 0
    s_add_u32 s40, s74, s61
    s_addc_u32 s41, s75, 0
    global_load_dwordx4 v[16:19], v90, s[74:75] offset:0
    global_load_dwordx4 v[20:23], v90, s[74:75] offset:1024
    global_load_dwordx4 v[24:27], v210, s[76:77] offset:0
    global_load_dwordx4 v[28:31], v210, s[76:77] offset:1024
    s_add_u32 m0, s25, 0
    s_nop 0
    buffer_load_dwordx4 v246, s[36:39], s24 offen lds
    s_add_u32 m0, s25, 0
    s_nop 0
    buffer_load_dwordx4 v247, s[36:39], s24 offen offset:1024 lds
    s_add_u32 s24, s24, 524288
    s_add_u32 m0, s100, 0
    s_nop 0
    buffer_load_dwordx4 v80, s[40:43], s26 offen offset:0 lds
    buffer_load_dwordx4 v81, s[40:43], s26 offen offset:1024 lds
    buffer_load_dwordx4 v82, s[40:43], s26 offen offset:2048 lds
    buffer_load_dwordx4 v83, s[40:43], s26 offen offset:3072 lds
    s_add_u32 s26, s26, 128
    s_add_u32 m0, s25, 16384
    s_nop 0
    buffer_load_dwordx4 v246, s[36:39], s24 offen lds
    s_add_u32 m0, s25, 16384
    s_nop 0
    buffer_load_dwordx4 v247, s[36:39], s24 offen offset:1024 lds
    s_add_u32 s24, s24, 524288
    s_setprio 0
    s_mov_b32 s34, s62
    s_mov_b32 s35, s60
    v_lshrrev_b32 v69, 6, v0
    v_and_b32 v68, 7, v1
    v_xor_b32 v68, v68, v69
    v_lshlrev_b32 v68, 4, v68
    v_lshl_add_u32 v68, v1, 7, v68
    v_add_u32 v68, 131072, v68
    v_lshrrev_b32 v85, 3, v0
    v_and_b32 v84, 7, v85
    v_and_b32 v86, 7, v0
    v_xor_b32 v84, v84, v86
    v_lshlrev_b32 v84, 4, v84
    v_lshl_add_u32 v84, v85, 8, v84
    s_lshr_b32 s60, s65, 1
    s_lshl_b32 s60, s60, 15
    s_and_b32 s61, s65, 1
    s_lshl_b32 s61, s61, 7
    s_add_u32 s60, s60, s61
    v_add_u32 v84, s60, v84
    v_add_u32 v85, 0x4000, v84
    v_lshlrev_b32 v86, 4, v0
    v_add_u32 v86, 131072, v86
    s_waitcnt vmcnt(10)
    v_mov_b32 v32, 0x3f803f80
    v_dot2_f32_bf16 v48, v16, v32, 0
    v_dot2_f32_bf16 v50, v16, v16, 0
    v_dot2_f32_bf16 v49, v17, v32, 0
    v_dot2_f32_bf16 v51, v17, v17, 0
    v_dot2_f32_bf16 v48, v18, v32, v48
    v_dot2_f32_bf16 v50, v18, v18, v50
    v_dot2_f32_bf16 v49, v19, v32, v49
    v_dot2_f32_bf16 v51, v19, v19, v51
    v_dot2_f32_bf16 v48, v20, v32, v48
    v_dot2_f32_bf16 v50, v20, v20, v50
    v_dot2_f32_bf16 v49, v21, v32, v49
    v_dot2_f32_bf16 v51, v21, v21, v51
    v_dot2_f32_bf16 v48, v22, v32, v48
    v_dot2_f32_bf16 v50, v22, v22, v50
    v_dot2_f32_bf16 v49, v23, v32, v49
    v_dot2_f32_bf16 v51, v23, v23, v51
    s_nop 1
    v_add_f32 v48, v48, v49
    v_add_f32 v50, v50, v51
    s_nop 0
    v_add_f32_dpp v48, v48, v48 quad_perm:[1,0,3,2] row_mask:0xf bank_mask:0xf
    v_add_f32_dpp v50, v50, v50 quad_perm:[1,0,3,2] row_mask:0xf bank_mask:0xf
    s_nop 0
    v_add_f32_dpp v48, v48, v48 quad_perm:[2,3,0,1] row_mask:0xf bank_mask:0xf
    v_add_f32_dpp v50, v50, v50 quad_perm:[2,3,0,1] row_mask:0xf bank_mask:0xf
    s_nop 0
    v_add_f32_dpp v48, v48, v48 row_half_mirror row_mask:0xf bank_mask:0xf
    v_add_f32_dpp v50, v50, v50 row_half_mirror row_mask:0xf bank_mask:0xf
    s_nop 0
    v_add_f32_dpp v48, v48, v48 row_mirror row_mask:0xf bank_mask:0xf
    v_add_f32_dpp v50, v50, v50 row_mirror row_mask:0xf bank_mask:0xf
    v_mov_b32 v49, v48
    v_mov_b32 v51, v50
    s_nop 0
    v_permlane16_swap_b32 v48, v49
    v_permlane16_swap_b32 v50, v51
    v_add_f32 v48, v48, v49
    v_add_f32 v50, v50, v51
    v_mov_b32 v49, v48
    v_mov_b32 v51, v50
    s_nop 0
    v_permlane32_swap_b32 v48, v49
    v_permlane32_swap_b32 v50, v51
    v_add_f32 v48, v48, v49
    v_add_f32 v50, v50, v51
    v_mul_f32 v48, 0x3a800000, v48
    v_mul_f32 v50, 0x3a800000, v50
    v_fma_f32 v50, -v48, v48, v50
    v_max_f32 v50, 0, v50
    v_cvt_pk_bf16_f32 v49, v48, v50
    v_lshlrev_b32 v48, 16, v49
    v_and_b32 v50, 0xffff0000, v49
    v_add_f32 v50, 0x3727c5ac, v50
    v_cvt_pk_bf16_f32 v50, v50, v50
    v_lshlrev_b32 v50, 16, v50
    v_sqrt_f32 v50, v50
    s_nop 0
    v_cvt_pk_bf16_f32 v70, v48, v50
    v_and_b32 v50, 0xffff0000, v70
    v_rcp_f32 v50, v50
    s_lshl_b32 s60, s3, 2
    s_add_u32 s60, s60, 147456
    v_mov_b32 v69, s60
    v_lshlrev_b32 v52, 16, v16
    v_and_b32 v53, 0xffff0000, v16
    v_lshlrev_b32 v54, 16, v17
    v_and_b32 v55, 0xffff0000, v17
    v_lshlrev_b32 v56, 16, v18
    v_and_b32 v57, 0xffff0000, v18
    v_lshlrev_b32 v58, 16, v19
    v_and_b32 v59, 0xffff0000, v19
    v_lshlrev_b32 v60, 16, v20
    v_and_b32 v61, 0xffff0000, v20
    v_lshlrev_b32 v62, 16, v21
    v_and_b32 v63, 0xffff0000, v21
    v_lshlrev_b32 v64, 16, v22
    v_and_b32 v65, 0xffff0000, v22
    v_lshlrev_b32 v66, 16, v23
    v_and_b32 v67, 0xffff0000, v23
    v_sub_f32 v52, v52, v48
    v_sub_f32 v53, v53, v48
    v_sub_f32 v54, v54, v48
    v_sub_f32 v55, v55, v48
    v_sub_f32 v56, v56, v48
    v_sub_f32 v57, v57, v48
    v_sub_f32 v58, v58, v48
    v_sub_f32 v59, v59, v48
    v_sub_f32 v60, v60, v48
    v_sub_f32 v61, v61, v48
    v_sub_f32 v62, v62, v48
    v_sub_f32 v63, v63, v48
    v_sub_f32 v64, v64, v48
    v_sub_f32 v65, v65, v48
    v_sub_f32 v66, v66, v48
    v_sub_f32 v67, v67, v48
    v_cvt_pk_bf16_f32 v16, v52, v53
    v_cvt_pk_bf16_f32 v17, v54, v55
    v_cvt_pk_bf16_f32 v18, v56, v57
    v_cvt_pk_bf16_f32 v19, v58, v59
    v_cvt_pk_bf16_f32 v20, v60, v61
    v_cvt_pk_bf16_f32 v21, v62, v63
    v_cvt_pk_bf16_f32 v22, v64, v65
    v_cvt_pk_bf16_f32 v23, v66, v67
    v_lshlrev_b32 v52, 16, v16
    v_and_b32 v53, 0xffff0000, v16
    v_lshlrev_b32 v54, 16, v17
    v_and_b32 v55, 0xffff0000, v17
    v_lshlrev_b32 v56, 16, v18
    v_and_b32 v57, 0xffff0000, v18
    v_lshlrev_b32 v58, 16, v19
    v_and_b32 v59, 0xffff0000, v19
    v_lshlrev_b32 v60, 16, v20
    v_and_b32 v61, 0xffff0000, v20
    v_lshlrev_b32 v62, 16, v21
    v_and_b32 v63, 0xffff0000, v21
    v_lshlrev_b32 v64, 16, v22
    v_and_b32 v65, 0xffff0000, v22
    v_lshlrev_b32 v66, 16, v23
    v_and_b32 v67, 0xffff0000, v23
    v_mul_f32 v52, v52, v50
    v_mul_f32 v53, v53, v50
    v_mul_f32 v54, v54, v50
    v_mul_f32 v55, v55, v50
    v_mul_f32 v56, v56, v50
    v_mul_f32 v57, v57, v50
    v_mul_f32 v58, v58, v50
    v_mul_f32 v59, v59, v50
    v_mul_f32 v60, v60, v50
    v_mul_f32 v61, v61, v50
    v_mul_f32 v62, v62, v50
    v_mul_f32 v63, v63, v50
    v_mul_f32 v64, v64, v50
    v_mul_f32 v65, v65, v50
    v_mul_f32 v66, v66, v50
    v_mul_f32 v67, v67, v50
    v_cvt_pk_bf16_f32 v16, v52, v53
    v_cvt_pk_bf16_f32 v17, v54, v55
    v_cvt_pk_bf16_f32 v18, v56, v57
    v_cvt_pk_bf16_f32 v19, v58, v59
    v_cvt_pk_bf16_f32 v20, v60, v61
    v_cvt_pk_bf16_f32 v21, v62, v63
    v_cvt_pk_bf16_f32 v22, v64, v65
    v_cvt_pk_bf16_f32 v23, v66, v67
    s_waitcnt vmcnt(8)
    v_dot2_f32_bf16 v48, v16, v24, 0
    v_dot2_f32_bf16 v51, v17, v25, 0
    v_dot2_f32_bf16 v48, v18, v26, v48
    v_dot2_f32_bf16 v51, v19, v27, v51
    v_dot2_f32_bf16 v48, v20, v28, v48
    v_dot2_f32_bf16 v51, v21, v29, v51
    v_dot2_f32_bf16 v48, v22, v30, v48
    v_dot2_f32_bf16 v51, v23, v31, v51
    s_nop 2
    v_add_f32 v48, v48, v51
    s_nop 1
    v_add_f32_dpp v48, v48, v48 quad_perm:[1,0,3,2] row_mask:0xf bank_mask:0xf
    s_nop 1
    v_add_f32_dpp v48, v48, v48 quad_perm:[2,3,0,1] row_mask:0xf bank_mask:0xf
    s_nop 1
    v_add_f32_dpp v48, v48, v48 row_half_mirror row_mask:0xf bank_mask:0xf
    s_nop 1
    v_add_f32_dpp v48, v48, v48 row_mirror row_mask:0xf bank_mask:0xf
    v_mov_b32 v49, v48
    s_nop 1
    v_permlane16_swap_b32 v48, v49
    v_add_f32 v48, v48, v49
    v_mov_b32 v49, v48
    s_nop 1
    v_permlane32_swap_b32 v48, v49
    v_add_f32 v48, v48, v49
    v_cvt_pk_bf16_f32 v48, v48, v48
    v_lshlrev_b32 v48, 16, v48
    v_ashrrev_i32 v49, 31, v48
    v_or_b32 v49, 0x80000000, v49
    v_xor_b32 v48, v48, v49
    v_and_b32 v48, 0xffff0000, v48
    s_lshl_b32 s61, s65, 3
    s_add_u32 s61, s61, s3
    s_sub_u32 s60, 2047, s61
    v_or_b32 v48, s60, v48
    v_mov_b32 v8, 0
    v_mov_b32 v9, 0
    ds_write_b128 v68, v[16:19]
    ds_write_b128 v68, v[20:23] offset:8192
    ds_write_b32 v69, v48
    s_mov_b32 s62, s34
    s_mov_b32 s60, s35
    s_add_u32 m0, s100, 32768
    s_nop 0
    buffer_load_dwordx4 v80, s[40:43], s26 offen offset:0 lds
    buffer_load_dwordx4 v81, s[40:43], s26 offen offset:1024 lds
    buffer_load_dwordx4 v82, s[40:43], s26 offen offset:2048 lds
    buffer_load_dwordx4 v83, s[40:43], s26 offen offset:3072 lds
    s_add_u32 s26, s26, 128
    s_add_u32 m0, s25, 32768
    s_nop 0
    buffer_load_dwordx4 v246, s[36:39], s24 offen lds
    s_add_u32 m0, s25, 32768
    s_nop 0
    buffer_load_dwordx4 v247, s[36:39], s24 offen offset:1024 lds
    s_add_u32 s24, s24, 524288
    s_or_b32 s63, s2, s3
    s_cmp_lg_u32 s63, 0
    s_cbranch_scc1 M_NONZ
    s_or_b32 s62, s62, 1
    v_mov_b32 v210, 0
    v_mov_b32 v211, s62
    s_mov_b64 exec, 1
    global_store_dword v210, v211, s[66:67] sc1
    s_mov_b64 exec, -1
M_NONZ:
    v_bfe_u32 v209, v0, 4, 3
    v_lshlrev_b32 v209, 13, v209
    v_lshrrev_b32 v88, 7, v0
    v_lshl_add_u32 v209, v88, 19, v209
    v_and_b32 v88, 15, v0
    v_lshl_add_u32 v209, v88, 4, v209
    s_lshl_b32 s62, s21, 16
    v_add_u32 v89, s62, v209
    s_mov_b32 s63, 2097152
    buffer_load_dwordx4 v[96:99], v89, s[36:39], s63 offen
    s_mov_b32 s63, 0
    buffer_load_dwordx4 v[92:95], v89, s[36:39], s63 offen
    v_bfe_u32 v249, v1, 1, 3
    v_xor_b32 v249, v249, v12
    v_lshlrev_b32 v249, 4, v249
    v_and_b32 v248, 15, v1
    v_lshl_add_u32 v248, v248, 7, v249
    v_add_u32 v248, s100, v248
    v_xor_b32 v249, 64, v248
    v_lshl_add_u32 v3, v15, 8, v13
    v_mul_u32_u24 v10, 57344, v12
    v_and_b32 v13, 15, v1
    v_lshl_add_u32 v10, v13, 4, v10
    v_and_b32 v12, 3, v1
    v_lshrrev_b32 v13, 2, v1
    v_lshlrev_b32 v13, 4, v13
    v_lshl_add_u32 v2, v12, 8, v13
    v_lshrrev_b32 v13, 4, v1
    v_lshlrev_b32 v244, 11, v13
    v_lshl_add_u32 v244, v15, 6, v244
    v_lshl_add_u32 v244, v12, 3, v244
    v_and_b32 v13, 1, v13
    v_lshl_add_u32 v244, v13, 5, v244
    v_xor_b32 v245, 32, v244
    v_bfe_u32 v12, v1, 1, 1
    v_and_b32 v14, 1, v1
    v_lshl_add_u32 v12, v14, 1, v12
    v_lshl_add_u32 v12, v13, 2, v12
    v_lshlrev_b32 v12, 3, v12
    v_lshl_add_u32 v12, v15, 6, v12
    v_lshrrev_b32 v13, 5, v1
    v_lshl_add_u32 v5, v13, 10, v12
    v_add_u32 v6, 65536, v5
    v_bfe_u32 v12, v1, 2, 3
    v_mul_u32_u24 v12, 1088, v12
    v_lshl_add_u32 v12, v13, 6, v12
    v_and_b32 v4, 3, v1
    v_lshl_add_u32 v4, v4, 4, v12
    v_add_u32 v11, 131072, v4
    v_add_u32 v4, 65536, v4
    v_bfe_u32 v12, v1, 4, 1
    v_lshlrev_b32 v12, 10, v12
    v_lshl_add_u32 v12, v13, 8, v12
    v_and_b32 v7, 15, v1
    v_lshl_add_u32 v7, v7, 4, v12
    s_lshl_b32 s60, s22, 19
    s_add_u32 s60, s60, 393216
    s_add_u32 s44, s4, s60
    s_addc_u32 s45, s5, 0
    s_mov_b32 s46, 0x20000
    s_mov_b32 s47, 0x20000
    s_add_u32 s48, s6, s60
    s_addc_u32 s49, s7, 0
    s_mov_b32 s50, 0x20000
    s_mov_b32 s51, 0x20000
    s_add_u32 s56, s18, 8388608
    s_addc_u32 s57, s19, 0
    s_mov_b32 s58, 0x1000000
    s_mov_b32 s59, 0x20000
    s_mul_i32 s28, s3, 1088
    s_lshl_b32 s30, s3, 10
    s_mov_b32 s27, s30
    s_mov_b32 s29, s30
    s_mov_b32 s23, 0
    s_mov_b32 s31, 0x05040100
    s_mov_b32 s32, 0x07060302
    s_lshr_b32 s60, s2, 2
    s_and_b32 s61, s2, 3
    s_cmp_ge_u32 s60, 28
    s_cselect_b32 s52, s14, s12
    s_cselect_b32 s53, s15, s13
    s_cselect_b32 s62, 28, 0
    s_sub_u32 s62, s60, s62
    s_lshl_b32 s62, s62, 8
    s_mul_i32 s63, s61, 1835008
    s_add_u32 s62, s62, s63
    s_add_u32 s52, s52, s62
    s_addc_u32 s53, s53, 0
    s_cmp_lt_u32 s2, 224
    s_cselect_b32 s54, 1828096, 0
    s_mov_b32 s55, 0x20000
    s_mul_i32 s101, s3, 229376
    s_lshl_b32 s64, s20, 19
    s_lshl_b32 s61, s21, 14
    s_add_u32 s64, s64, s61
    s_lshl_b32 s61, s3, 11
    s_add_u32 s64, s64, s61
    s_waitcnt vmcnt(8)
    s_waitcnt lgkmcnt(0)
    s_barrier
    ds_read_b64_tr_b16 v[176:177], v244 offset:0
    ds_read_b64_tr_b16 v[178:179], v244 offset:1024
    ds_read_b64_tr_b16 v[180:181], v244 offset:8192
    ds_read_b64_tr_b16 v[182:183], v244 offset:9216
    ds_read_b128 v[212:215], v248 offset:0
    ds_read_b128 v[216:219], v249 offset:0
    ds_read_b64_tr_b16 v[184:185], v245 offset:0
    ds_read_b64_tr_b16 v[186:187], v245 offset:1024
    ds_read_b64_tr_b16 v[188:189], v245 offset:8192
    ds_read_b64_tr_b16 v[190:191], v245 offset:9216
    ds_read_b128 v[220:223], v248 offset:2048
    ds_read_b128 v[224:227], v249 offset:2048
    s_waitcnt lgkmcnt(7)
    v_mfma_f32_16x16x32_bf16 v[112:115], v[176:179], v[212:215], 0
    ds_read_b64_tr_b16 v[192:193], v244 offset:256
    s_waitcnt lgkmcnt(7)
    v_mfma_f32_16x16x32_bf16 v[112:115], v[180:183], v[216:219], v[112:115]
    ds_read_b64_tr_b16 v[194:195], v244 offset:1280
    s_waitcnt lgkmcnt(3)
    v_mfma_f32_16x16x32_bf16 v[116:119], v[176:179], v[220:223], 0
    ds_read_b64_tr_b16 v[196:197], v244 offset:8448
    s_waitcnt lgkmcnt(3)
    v_mfma_f32_16x16x32_bf16 v[116:119], v[180:183], v[224:227], v[116:119]
    ds_read_b64_tr_b16 v[198:199], v244 offset:9472
    s_add_u32 m0, s100, 0
    s_nop 0
    buffer_load_dwordx4 v80, s[40:43], s26 offen offset:0 lds
    v_mfma_f32_16x16x32_bf16 v[120:123], v[184:187], v[212:215], 0
    ds_read_b64_tr_b16 v[200:201], v245 offset:256
    v_mfma_f32_16x16x32_bf16 v[120:123], v[188:191], v[216:219], v[120:123]
    ds_read_b64_tr_b16 v[202:203], v245 offset:1280
    v_mfma_f32_16x16x32_bf16 v[124:127], v[184:187], v[220:223], 0
    ds_read_b64_tr_b16 v[204:205], v245 offset:8448
    v_mfma_f32_16x16x32_bf16 v[124:127], v[188:191], v[224:227], v[124:127]
    ds_read_b64_tr_b16 v[206:207], v245 offset:9472
    buffer_load_dwordx4 v81, s[40:43], s26 offen offset:1024 lds
    s_waitcnt lgkmcnt(6)
    v_mfma_f32_16x16x32_bf16 v[128:131], v[192:195], v[212:215], 0
    ds_read_b64_tr_b16 v[176:177], v244 offset:512
    s_waitcnt lgkmcnt(5)
    v_mfma_f32_16x16x32_bf16 v[128:131], v[196:199], v[216:219], v[128:131]
    ds_read_b64_tr_b16 v[178:179], v244 offset:1536
    v_mfma_f32_16x16x32_bf16 v[132:135], v[192:195], v[220:223], 0
    ds_read_b64_tr_b16 v[180:181], v244 offset:8704
    v_mfma_f32_16x16x32_bf16 v[132:135], v[196:199], v[224:227], v[132:135]
    ds_read_b64_tr_b16 v[182:183], v244 offset:9728
    buffer_load_dwordx4 v82, s[40:43], s26 offen offset:2048 lds
    s_waitcnt lgkmcnt(6)
    v_mfma_f32_16x16x32_bf16 v[136:139], v[200:203], v[212:215], 0
    ds_read_b64_tr_b16 v[184:185], v245 offset:512
    s_waitcnt lgkmcnt(5)
    v_mfma_f32_16x16x32_bf16 v[136:139], v[204:207], v[216:219], v[136:139]
    ds_read_b64_tr_b16 v[186:187], v245 offset:1536
    v_mfma_f32_16x16x32_bf16 v[140:143], v[200:203], v[220:223], 0
    ds_read_b64_tr_b16 v[188:189], v245 offset:8704
    v_mfma_f32_16x16x32_bf16 v[140:143], v[204:207], v[224:227], v[140:143]
    ds_read_b64_tr_b16 v[190:191], v245 offset:9728
    buffer_load_dwordx4 v83, s[40:43], s26 offen offset:3072 lds
    s_add_u32 s26, s26, 128
    s_waitcnt lgkmcnt(6)
    v_mfma_f32_16x16x32_bf16 v[144:147], v[176:179], v[212:215], 0
    ds_read_b64_tr_b16 v[192:193], v244 offset:768
    s_waitcnt lgkmcnt(5)
    v_mfma_f32_16x16x32_bf16 v[144:147], v[180:183], v[216:219], v[144:147]
    ds_read_b64_tr_b16 v[194:195], v244 offset:1792
    v_mfma_f32_16x16x32_bf16 v[148:151], v[176:179], v[220:223], 0
    ds_read_b64_tr_b16 v[196:197], v244 offset:8960
    v_mfma_f32_16x16x32_bf16 v[148:151], v[180:183], v[224:227], v[148:151]
    ds_read_b64_tr_b16 v[198:199], v244 offset:9984
    s_add_u32 m0, s25, 49152
    s_nop 0
    buffer_load_dwordx4 v246, s[36:39], s24 offen lds
    s_waitcnt lgkmcnt(6)
    v_mfma_f32_16x16x32_bf16 v[152:155], v[184:187], v[212:215], 0
    ds_read_b64_tr_b16 v[200:201], v245 offset:768
    s_waitcnt lgkmcnt(5)
    v_mfma_f32_16x16x32_bf16 v[152:155], v[188:191], v[216:219], v[152:155]
    ds_read_b64_tr_b16 v[202:203], v245 offset:1792
    v_mfma_f32_16x16x32_bf16 v[156:159], v[184:187], v[220:223], 0
    ds_read_b64_tr_b16 v[204:205], v245 offset:8960
    v_mfma_f32_16x16x32_bf16 v[156:159], v[188:191], v[224:227], v[156:159]
    ds_read_b64_tr_b16 v[206:207], v245 offset:9984
    s_add_u32 m0, s25, 49152
    s_nop 0
    buffer_load_dwordx4 v247, s[36:39], s24 offen offset:1024 lds
    s_add_u32 s24, s24, 524288
    s_waitcnt lgkmcnt(6)
    v_mfma_f32_16x16x32_bf16 v[160:163], v[192:195], v[212:215], 0
    ds_read_b64_tr_b16 v[176:177], v244 offset:16384
    s_waitcnt lgkmcnt(5)
    v_mfma_f32_16x16x32_bf16 v[160:163], v[196:199], v[216:219], v[160:163]
    ds_read_b64_tr_b16 v[178:179], v244 offset:17408
    v_mfma_f32_16x16x32_bf16 v[164:167], v[192:195], v[220:223], 0
    ds_read_b64_tr_b16 v[180:181], v244 offset:24576
    v_mfma_f32_16x16x32_bf16 v[164:167], v[196:199], v[224:227], v[164:167]
    ds_read_b64_tr_b16 v[182:183], v244 offset:25600
    s_waitcnt vmcnt(10)
    ds_read_b128 v[228:231], v248 offset:32768
    ds_read_b128 v[232:235], v249 offset:32768
    s_waitcnt lgkmcnt(8)
    v_mfma_f32_16x16x32_bf16 v[168:171], v[200:203], v[212:215], 0
    ds_read_b64_tr_b16 v[184:185], v245 offset:16384
    s_waitcnt lgkmcnt(7)
    v_mfma_f32_16x16x32_bf16 v[168:171], v[204:207], v[216:219], v[168:171]
    ds_read_b64_tr_b16 v[186:187], v245 offset:17408
    v_mfma_f32_16x16x32_bf16 v[172:175], v[200:203], v[220:223], 0
    ds_read_b64_tr_b16 v[188:189], v245 offset:24576
    v_mfma_f32_16x16x32_bf16 v[172:175], v[204:207], v[224:227], v[172:175]
    ds_read_b64_tr_b16 v[190:191], v245 offset:25600
    ds_read_b128 v[236:239], v248 offset:34816
    ds_read_b128 v[240:243], v249 offset:34816
    s_waitcnt vmcnt(8)
    s_barrier
    s_waitcnt lgkmcnt(7)
    v_mfma_f32_16x16x32_bf16 v[112:115], v[176:179], v[228:231], v[112:115]
    ds_read_b64_tr_b16 v[192:193], v244 offset:16640
    ds_read_b128 v[16:19], v86
    s_waitcnt lgkmcnt(8)
    v_mfma_f32_16x16x32_bf16 v[112:115], v[180:183], v[232:235], v[112:115]
    ds_read_b64_tr_b16 v[194:195], v244 offset:17664
    ds_read_b128 v[20:23], v86 offset:8192
    s_waitcnt lgkmcnt(5)
    v_mfma_f32_16x16x32_bf16 v[116:119], v[176:179], v[236:239], v[116:119]
    ds_read_b64_tr_b16 v[196:197], v244 offset:24832
    v_mov_b32 v87, 147456
    s_waitcnt lgkmcnt(5)
    v_mfma_f32_16x16x32_bf16 v[116:119], v[180:183], v[240:243], v[116:119]
    ds_read_b64_tr_b16 v[198:199], v244 offset:25856
    ds_read_b128 v[24:27], v87
    s_add_u32 m0, s100, 32768
    s_nop 0
    buffer_load_dwordx4 v80, s[40:43], s26 offen offset:0 lds
    v_mfma_f32_16x16x32_bf16 v[120:123], v[184:187], v[228:231], v[120:123]
    ds_read_b64_tr_b16 v[200:201], v245 offset:16640
    s_nop 0
    v_mfma_f32_16x16x32_bf16 v[120:123], v[188:191], v[232:235], v[120:123]
    ds_read_b64_tr_b16 v[202:203], v245 offset:17664
    s_nop 0
    v_mfma_f32_16x16x32_bf16 v[124:127], v[184:187], v[236:239], v[124:127]
    ds_read_b64_tr_b16 v[204:205], v245 offset:24832
    s_nop 0
    v_mfma_f32_16x16x32_bf16 v[124:127], v[188:191], v[240:243], v[124:127]
    ds_read_b64_tr_b16 v[206:207], v245 offset:25856
    s_nop 0
    buffer_load_dwordx4 v81, s[40:43], s26 offen offset:1024 lds
    s_waitcnt lgkmcnt(8)
    v_mfma_f32_16x16x32_bf16 v[128:131], v[192:195], v[228:231], v[128:131]
    ds_read_b64_tr_b16 v[176:177], v244 offset:16896
    s_waitcnt lgkmcnt(6)
    v_mfma_f32_16x16x32_bf16 v[128:131], v[196:199], v[232:235], v[128:131]
    ds_read_b64_tr_b16 v[178:179], v244 offset:17920
    global_store_dwordx4 v84, v[16:19], s[18:19] sc1
    v_mfma_f32_16x16x32_bf16 v[132:135], v[192:195], v[236:239], v[132:135]
    ds_read_b64_tr_b16 v[180:181], v244 offset:25088
    ds_read_b128 v[28:31], v87 offset:16
    v_mfma_f32_16x16x32_bf16 v[132:135], v[196:199], v[240:243], v[132:135]
    ds_read_b64_tr_b16 v[182:183], v244 offset:26112
    buffer_load_dwordx4 v82, s[40:43], s26 offen offset:2048 lds
    s_waitcnt lgkmcnt(7)
    v_mfma_f32_16x16x32_bf16 v[136:139], v[200:203], v[228:231], v[136:139]
    ds_read_b64_tr_b16 v[184:185], v245 offset:16896
    global_store_dwordx4 v85, v[20:23], s[18:19] sc1
    s_waitcnt lgkmcnt(6)
    v_mfma_f32_16x16x32_bf16 v[136:139], v[204:207], v[232:235], v[136:139]
    ds_read_b64_tr_b16 v[186:187], v245 offset:17920
    s_nop 0
    v_mfma_f32_16x16x32_bf16 v[140:143], v[200:203], v[236:239], v[140:143]
    ds_read_b64_tr_b16 v[188:189], v245 offset:25088
    s_nop 0
    v_mfma_f32_16x16x32_bf16 v[140:143], v[204:207], v[240:243], v[140:143]
    ds_read_b64_tr_b16 v[190:191], v245 offset:26112
    s_nop 0
    buffer_load_dwordx4 v83, s[40:43], s26 offen offset:3072 lds
    s_add_u32 s26, s26, 128
    s_waitcnt lgkmcnt(7)
    v_mfma_f32_16x16x32_bf16 v[144:147], v[176:179], v[228:231], v[144:147]
    ds_read_b64_tr_b16 v[192:193], v244 offset:17152
    s_nop 0
    s_waitcnt lgkmcnt(5)
    v_mfma_f32_16x16x32_bf16 v[144:147], v[180:183], v[232:235], v[144:147]
    ds_read_b64_tr_b16 v[194:195], v244 offset:18176
    v_mfma_f32_16x16x32_bf16 v[148:151], v[176:179], v[236:239], v[148:151]
    ds_read_b64_tr_b16 v[196:197], v244 offset:25344
    v_max3_u32 v24, v24, v25, v26
    v_mfma_f32_16x16x32_bf16 v[148:151], v[180:183], v[240:243], v[148:151]
    ds_read_b64_tr_b16 v[198:199], v244 offset:26368
    v_max3_u32 v28, v28, v29, v30
    s_add_u32 m0, s25, 0
    s_nop 0
    buffer_load_dwordx4 v246, s[36:39], s24 offen lds
    s_waitcnt lgkmcnt(6)
    v_mfma_f32_16x16x32_bf16 v[152:155], v[184:187], v[228:231], v[152:155]
    ds_read_b64_tr_b16 v[200:201], v245 offset:17152
    v_max3_u32 v24, v24, v27, v31
    s_waitcnt lgkmcnt(5)
    v_mfma_f32_16x16x32_bf16 v[152:155], v[188:191], v[232:235], v[152:155]
    ds_read_b64_tr_b16 v[202:203], v245 offset:18176
    v_max_u32 v24, v24, v28
    v_mfma_f32_16x16x32_bf16 v[156:159], v[184:187], v[236:239], v[156:159]
    ds_read_b64_tr_b16 v[204:205], v245 offset:25344
    v_readfirstlane_b32 s34, v24
    v_mfma_f32_16x16x32_bf16 v[156:159], v[188:191], v[240:243], v[156:159]
    ds_read_b64_tr_b16 v[206:207], v245 offset:26368
    s_add_u32 m0, s25, 0
    s_nop 0
    buffer_load_dwordx4 v247, s[36:39], s24 offen offset:1024 lds
    s_add_u32 s24, s24, 524288
    s_waitcnt lgkmcnt(6)
    v_mfma_f32_16x16x32_bf16 v[160:163], v[192:195], v[228:231], v[160:163]
    ds_read_b64_tr_b16 v[176:177], v244 offset:32768
    s_waitcnt lgkmcnt(5)
    v_mfma_f32_16x16x32_bf16 v[160:163], v[196:199], v[232:235], v[160:163]
    ds_read_b64_tr_b16 v[178:179], v244 offset:33792
    v_mfma_f32_16x16x32_bf16 v[164:167], v[192:195], v[236:239], v[164:167]
    ds_read_b64_tr_b16 v[180:181], v244 offset:40960
    v_mfma_f32_16x16x32_bf16 v[164:167], v[196:199], v[240:243], v[164:167]
    ds_read_b64_tr_b16 v[182:183], v244 offset:41984
    s_mov_b32 s63, 4194304
    buffer_load_dwordx4 v[100:103], v89, s[36:39], s63 offen
    s_waitcnt vmcnt(11)
    ds_read_b128 v[212:215], v248 offset:0
    ds_read_b128 v[216:219], v249 offset:0
    s_waitcnt lgkmcnt(8)
    v_mfma_f32_16x16x32_bf16 v[168:171], v[200:203], v[228:231], v[168:171]
    ds_read_b64_tr_b16 v[184:185], v245 offset:32768
    s_waitcnt lgkmcnt(7)
    v_mfma_f32_16x16x32_bf16 v[168:171], v[204:207], v[232:235], v[168:171]
    ds_read_b64_tr_b16 v[186:187], v245 offset:33792
    v_mfma_f32_16x16x32_bf16 v[172:175], v[200:203], v[236:239], v[172:175]
    ds_read_b64_tr_b16 v[188:189], v245 offset:40960
    v_mfma_f32_16x16x32_bf16 v[172:175], v[204:207], v[240:243], v[172:175]
    ds_read_b64_tr_b16 v[190:191], v245 offset:41984
    s_cmp_lg_u32 s3, 0
    s_cbranch_scc1 M_NL1
    v_mov_b32 v210, 0
    global_load_dword v88, v210, s[66:67] sc1
M_NL1:
    ds_read_b128 v[220:223], v248 offset:2048
    ds_read_b128 v[224:227], v249 offset:2048
    s_waitcnt vmcnt(9)
    s_barrier
    s_waitcnt lgkmcnt(7)
    v_mfma_f32_16x16x32_bf16 v[112:115], v[176:179], v[212:215], v[112:115]
    ds_read_b64_tr_b16 v[192:193], v244 offset:33024
    s_waitcnt lgkmcnt(7)
    v_mfma_f32_16x16x32_bf16 v[112:115], v[180:183], v[216:219], v[112:115]
    ds_read_b64_tr_b16 v[194:195], v244 offset:34048
    s_waitcnt lgkmcnt(3)
    v_mfma_f32_16x16x32_bf16 v[116:119], v[176:179], v[220:223], v[116:119]
    ds_read_b64_tr_b16 v[196:197], v244 offset:41216
    s_waitcnt lgkmcnt(3)
    v_mfma_f32_16x16x32_bf16 v[116:119], v[180:183], v[224:227], v[116:119]
    ds_read_b64_tr_b16 v[198:199], v244 offset:42240
    s_add_u32 m0, s100, 0
    s_nop 0
    buffer_load_dwordx4 v80, s[40:43], s26 offen offset:0 lds
    v_mfma_f32_16x16x32_bf16 v[120:123], v[184:187], v[212:215], v[120:123]
    ds_read_b64_tr_b16 v[200:201], v245 offset:33024
    v_mfma_f32_16x16x32_bf16 v[120:123], v[188:191], v[216:219], v[120:123]
    ds_read_b64_tr_b16 v[202:203], v245 offset:34048
    v_mfma_f32_16x16x32_bf16 v[124:127], v[184:187], v[220:223], v[124:127]
    ds_read_b64_tr_b16 v[204:205], v245 offset:41216
    v_mfma_f32_16x16x32_bf16 v[124:127], v[188:191], v[224:227], v[124:127]
    ds_read_b64_tr_b16 v[206:207], v245 offset:42240
    buffer_load_dwordx4 v81, s[40:43], s26 offen offset:1024 lds
    s_waitcnt lgkmcnt(6)
    v_mfma_f32_16x16x32_bf16 v[128:131], v[192:195], v[212:215], v[128:131]
    ds_read_b64_tr_b16 v[176:177], v244 offset:33280
    s_waitcnt lgkmcnt(5)
    v_mfma_f32_16x16x32_bf16 v[128:131], v[196:199], v[216:219], v[128:131]
    ds_read_b64_tr_b16 v[178:179], v244 offset:34304
    v_mfma_f32_16x16x32_bf16 v[132:135], v[192:195], v[220:223], v[132:135]
    ds_read_b64_tr_b16 v[180:181], v244 offset:41472
    v_mfma_f32_16x16x32_bf16 v[132:135], v[196:199], v[224:227], v[132:135]
    ds_read_b64_tr_b16 v[182:183], v244 offset:42496
    buffer_load_dwordx4 v82, s[40:43], s26 offen offset:2048 lds
    s_waitcnt lgkmcnt(6)
    v_mfma_f32_16x16x32_bf16 v[136:139], v[200:203], v[212:215], v[136:139]
    ds_read_b64_tr_b16 v[184:185], v245 offset:33280
    s_waitcnt lgkmcnt(5)
    v_mfma_f32_16x16x32_bf16 v[136:139], v[204:207], v[216:219], v[136:139]
    ds_read_b64_tr_b16 v[186:187], v245 offset:34304
    v_mfma_f32_16x16x32_bf16 v[140:143], v[200:203], v[220:223], v[140:143]
    ds_read_b64_tr_b16 v[188:189], v245 offset:41472
    v_mfma_f32_16x16x32_bf16 v[140:143], v[204:207], v[224:227], v[140:143]
    ds_read_b64_tr_b16 v[190:191], v245 offset:42496
    buffer_load_dwordx4 v83, s[40:43], s26 offen offset:3072 lds
    s_add_u32 s26, s26, 128
    s_waitcnt lgkmcnt(6)
    v_mfma_f32_16x16x32_bf16 v[144:147], v[176:179], v[212:215], v[144:147]
    ds_read_b64_tr_b16 v[192:193], v244 offset:33536
    s_waitcnt lgkmcnt(5)
    v_mfma_f32_16x16x32_bf16 v[144:147], v[180:183], v[216:219], v[144:147]
    ds_read_b64_tr_b16 v[194:195], v244 offset:34560
    v_mfma_f32_16x16x32_bf16 v[148:151], v[176:179], v[220:223], v[148:151]
    ds_read_b64_tr_b16 v[196:197], v244 offset:41728
    v_mfma_f32_16x16x32_bf16 v[148:151], v[180:183], v[224:227], v[148:151]
    ds_read_b64_tr_b16 v[198:199], v244 offset:42752
    s_add_u32 m0, s25, 16384
    s_nop 0
    buffer_load_dwordx4 v246, s[36:39], s24 offen lds
    s_waitcnt lgkmcnt(6)
    v_mfma_f32_16x16x32_bf16 v[152:155], v[184:187], v[212:215], v[152:155]
    ds_read_b64_tr_b16 v[200:201], v245 offset:33536
    s_waitcnt lgkmcnt(5)
    v_mfma_f32_16x16x32_bf16 v[152:155], v[188:191], v[216:219], v[152:155]
    ds_read_b64_tr_b16 v[202:203], v245 offset:34560
    v_mfma_f32_16x16x32_bf16 v[156:159], v[184:187], v[220:223], v[156:159]
    ds_read_b64_tr_b16 v[204:205], v245 offset:41728
    v_mfma_f32_16x16x32_bf16 v[156:159], v[188:191], v[224:227], v[156:159]
    ds_read_b64_tr_b16 v[206:207], v245 offset:42752
    s_add_u32 m0, s25, 16384
    s_nop 0
    buffer_load_dwordx4 v247, s[36:39], s24 offen offset:1024 lds
    s_add_u32 s24, s24, 524288
    s_waitcnt lgkmcnt(6)
    v_mfma_f32_16x16x32_bf16 v[160:163], v[192:195], v[212:215], v[160:163]
    ds_read_b64_tr_b16 v[176:177], v244 offset:49152
    s_waitcnt lgkmcnt(5)
    v_mfma_f32_16x16x32_bf16 v[160:163], v[196:199], v[216:219], v[160:163]
    ds_read_b64_tr_b16 v[178:179], v244 offset:50176
    v_mfma_f32_16x16x32_bf16 v[164:167], v[192:195], v[220:223], v[164:167]
    ds_read_b64_tr_b16 v[180:181], v244 offset:57344
    v_mfma_f32_16x16x32_bf16 v[164:167], v[196:199], v[224:227], v[164:167]
    ds_read_b64_tr_b16 v[182:183], v244 offset:58368
    s_mov_b32 s63, 6291456
    buffer_load_dwordx4 v[104:107], v89, s[36:39], s63 offen
    s_waitcnt vmcnt(10)
    ds_read_b128 v[228:231], v248 offset:32768
    ds_read_b128 v[232:235], v249 offset:32768
    s_waitcnt lgkmcnt(8)
    v_mfma_f32_16x16x32_bf16 v[168:171], v[200:203], v[212:215], v[168:171]
    ds_read_b64_tr_b16 v[184:185], v245 offset:49152
    s_waitcnt lgkmcnt(7)
    v_mfma_f32_16x16x32_bf16 v[168:171], v[204:207], v[216:219], v[168:171]
    ds_read_b64_tr_b16 v[186:187], v245 offset:50176
    v_mfma_f32_16x16x32_bf16 v[172:175], v[200:203], v[220:223], v[172:175]
    ds_read_b64_tr_b16 v[188:189], v245 offset:57344
    v_mfma_f32_16x16x32_bf16 v[172:175], v[204:207], v[224:227], v[172:175]
    ds_read_b64_tr_b16 v[190:191], v245 offset:58368
    s_lshr_b32 s62, s65, 6
    s_lshl_b32 s62, s62, 19
    s_and_b32 s63, s65, 63
    s_lshl_b32 s63, s63, 11
    s_add_u32 s62, s62, s63
    s_add_u32 s62, s62, 393216
    v_lshlrev_b32 v211, 2, v0
    v_add_u32 v211, s62, v211
    global_load_dword v208, v211, s[4:5]
    ds_read_b128 v[236:239], v248 offset:34816
    ds_read_b128 v[240:243], v249 offset:34816
    s_waitcnt vmcnt(9)
    s_barrier
    s_waitcnt lgkmcnt(7)
    v_mfma_f32_16x16x32_bf16 v[112:115], v[176:179], v[228:231], v[112:115]
    ds_read_b64_tr_b16 v[192:193], v244 offset:49408
    s_waitcnt lgkmcnt(7)
    v_mfma_f32_16x16x32_bf16 v[112:115], v[180:183], v[232:235], v[112:115]
    ds_read_b64_tr_b16 v[194:195], v244 offset:50432
    s_waitcnt lgkmcnt(3)
    v_mfma_f32_16x16x32_bf16 v[116:119], v[176:179], v[236:239], v[116:119]
    ds_read_b64_tr_b16 v[196:197], v244 offset:57600
    s_waitcnt lgkmcnt(3)
    v_mfma_f32_16x16x32_bf16 v[116:119], v[180:183], v[240:243], v[116:119]
    ds_read_b64_tr_b16 v[198:199], v244 offset:58624
    s_add_u32 m0, s100, 32768
    s_nop 0
    buffer_load_dwordx4 v80, s[40:43], s26 offen offset:0 lds
    v_mfma_f32_16x16x32_bf16 v[120:123], v[184:187], v[228:231], v[120:123]
    ds_read_b64_tr_b16 v[200:201], v245 offset:49408
    v_mfma_f32_16x16x32_bf16 v[120:123], v[188:191], v[232:235], v[120:123]
    ds_read_b64_tr_b16 v[202:203], v245 offset:50432
    v_mfma_f32_16x16x32_bf16 v[124:127], v[184:187], v[236:239], v[124:127]
    ds_read_b64_tr_b16 v[204:205], v245 offset:57600
    v_mfma_f32_16x16x32_bf16 v[124:127], v[188:191], v[240:243], v[124:127]
    ds_read_b64_tr_b16 v[206:207], v245 offset:58624
    buffer_load_dwordx4 v81, s[40:43], s26 offen offset:1024 lds
    s_waitcnt lgkmcnt(6)
    v_mfma_f32_16x16x32_bf16 v[128:131], v[192:195], v[228:231], v[128:131]
    ds_read_b64_tr_b16 v[176:177], v244 offset:49664
    s_waitcnt lgkmcnt(5)
    v_mfma_f32_16x16x32_bf16 v[128:131], v[196:199], v[232:235], v[128:131]
    ds_read_b64_tr_b16 v[178:179], v244 offset:50688
    v_mfma_f32_16x16x32_bf16 v[132:135], v[192:195], v[236:239], v[132:135]
    ds_read_b64_tr_b16 v[180:181], v244 offset:57856
    v_mfma_f32_16x16x32_bf16 v[132:135], v[196:199], v[240:243], v[132:135]
    ds_read_b64_tr_b16 v[182:183], v244 offset:58880
    buffer_load_dwordx4 v82, s[40:43], s26 offen offset:2048 lds
    s_waitcnt lgkmcnt(6)
    v_mfma_f32_16x16x32_bf16 v[136:139], v[200:203], v[228:231], v[136:139]
    ds_read_b64_tr_b16 v[184:185], v245 offset:49664
    s_waitcnt lgkmcnt(5)
    v_mfma_f32_16x16x32_bf16 v[136:139], v[204:207], v[232:235], v[136:139]
    ds_read_b64_tr_b16 v[186:187], v245 offset:50688
    v_mfma_f32_16x16x32_bf16 v[140:143], v[200:203], v[236:239], v[140:143]
    ds_read_b64_tr_b16 v[188:189], v245 offset:57856
    v_mfma_f32_16x16x32_bf16 v[140:143], v[204:207], v[240:243], v[140:143]
    ds_read_b64_tr_b16 v[190:191], v245 offset:58880
    buffer_load_dwordx4 v83, s[40:43], s26 offen offset:3072 lds
    s_add_u32 s26, s26, 128
    s_waitcnt lgkmcnt(6)
    v_mfma_f32_16x16x32_bf16 v[144:147], v[176:179], v[228:231], v[144:147]
    ds_read_b64_tr_b16 v[192:193], v244 offset:49920
    s_waitcnt lgkmcnt(5)
    v_mfma_f32_16x16x32_bf16 v[144:147], v[180:183], v[232:235], v[144:147]
    ds_read_b64_tr_b16 v[194:195], v244 offset:50944
    v_mfma_f32_16x16x32_bf16 v[148:151], v[176:179], v[236:239], v[148:151]
    ds_read_b64_tr_b16 v[196:197], v244 offset:58112
    v_mfma_f32_16x16x32_bf16 v[148:151], v[180:183], v[240:243], v[148:151]
    ds_read_b64_tr_b16 v[198:199], v244 offset:59136
    s_add_u32 m0, s25, 32768
    s_nop 0
    buffer_load_dwordx4 v246, s[36:39], s24 offen lds
    s_waitcnt lgkmcnt(6)
    v_mfma_f32_16x16x32_bf16 v[152:155], v[184:187], v[228:231], v[152:155]
    ds_read_b64_tr_b16 v[200:201], v245 offset:49920
    s_waitcnt lgkmcnt(5)
    v_mfma_f32_16x16x32_bf16 v[152:155], v[188:191], v[232:235], v[152:155]
    ds_read_b64_tr_b16 v[202:203], v245 offset:50944
    v_mfma_f32_16x16x32_bf16 v[156:159], v[184:187], v[236:239], v[156:159]
    ds_read_b64_tr_b16 v[204:205], v245 offset:58112
    v_mfma_f32_16x16x32_bf16 v[156:159], v[188:191], v[240:243], v[156:159]
    ds_read_b64_tr_b16 v[206:207], v245 offset:59136
    s_add_u32 m0, s25, 32768
    s_nop 0
    buffer_load_dwordx4 v247, s[36:39], s24 offen offset:1024 lds
    s_add_u32 s24, s24, 524288
    s_waitcnt lgkmcnt(6)
    v_mfma_f32_16x16x32_bf16 v[160:163], v[192:195], v[228:231], v[160:163]
    ds_read_b64_tr_b16 v[176:177], v244 offset:0
    s_waitcnt lgkmcnt(5)
    v_mfma_f32_16x16x32_bf16 v[160:163], v[196:199], v[232:235], v[160:163]
    ds_read_b64_tr_b16 v[178:179], v244 offset:1024
    v_mfma_f32_16x16x32_bf16 v[164:167], v[192:195], v[236:239], v[164:167]
    ds_read_b64_tr_b16 v[180:181], v244 offset:8192
    v_mfma_f32_16x16x32_bf16 v[164:167], v[196:199], v[240:243], v[164:167]
    ds_read_b64_tr_b16 v[182:183], v244 offset:9216
    global_load_dword v208, v211, s[6:7]
    s_waitcnt vmcnt(11)
    ds_read_b128 v[212:215], v248 offset:0
    ds_read_b128 v[216:219], v249 offset:0
    s_waitcnt lgkmcnt(8)
    v_mfma_f32_16x16x32_bf16 v[168:171], v[200:203], v[228:231], v[168:171]
    ds_read_b64_tr_b16 v[184:185], v245 offset:0
    s_waitcnt lgkmcnt(7)
    v_mfma_f32_16x16x32_bf16 v[168:171], v[204:207], v[232:235], v[168:171]
    ds_read_b64_tr_b16 v[186:187], v245 offset:1024
    v_mfma_f32_16x16x32_bf16 v[172:175], v[200:203], v[236:239], v[172:175]
    ds_read_b64_tr_b16 v[188:189], v245 offset:8192
    v_mfma_f32_16x16x32_bf16 v[172:175], v[204:207], v[240:243], v[172:175]
    ds_read_b64_tr_b16 v[190:191], v245 offset:9216
    ds_read_b128 v[220:223], v248 offset:2048
    ds_read_b128 v[224:227], v249 offset:2048
    s_waitcnt vmcnt(9)
    s_barrier
    s_waitcnt lgkmcnt(7)
    v_mfma_f32_16x16x32_bf16 v[112:115], v[176:179], v[212:215], v[112:115]
    ds_read_b64_tr_b16 v[192:193], v244 offset:256
    s_waitcnt vmcnt(8)
    s_waitcnt lgkmcnt(7)
    v_mfma_f32_16x16x32_bf16 v[112:115], v[180:183], v[216:219], v[112:115]
    ds_read_b64_tr_b16 v[194:195], v244 offset:1280
    v_lshlrev_b32 v72, 16, v92
    s_waitcnt lgkmcnt(3)
    v_mfma_f32_16x16x32_bf16 v[116:119], v[176:179], v[220:223], v[116:119]
    ds_read_b64_tr_b16 v[196:197], v244 offset:8448
    v_and_b32 v73, 0xffff0000, v92
    s_waitcnt lgkmcnt(3)
    v_mfma_f32_16x16x32_bf16 v[116:119], v[180:183], v[224:227], v[116:119]
    ds_read_b64_tr_b16 v[198:199], v244 offset:9472
    v_lshlrev_b32 v74, 16, v93
    s_add_u32 m0, s100, 0
    s_nop 0
    buffer_load_dwordx4 v80, s[40:43], s26 offen offset:0 lds
    v_mfma_f32_16x16x32_bf16 v[120:123], v[184:187], v[212:215], v[120:123]
    ds_read_b64_tr_b16 v[200:201], v245 offset:256
    v_and_b32 v75, 0xffff0000, v93
    v_mfma_f32_16x16x32_bf16 v[120:123], v[188:191], v[216:219], v[120:123]
    ds_read_b64_tr_b16 v[202:203], v245 offset:1280
    v_lshlrev_b32 v76, 16, v94
    v_mfma_f32_16x16x32_bf16 v[124:127], v[184:187], v[220:223], v[124:127]
    ds_read_b64_tr_b16 v[204:205], v245 offset:8448
    v_and_b32 v77, 0xffff0000, v94
    v_mfma_f32_16x16x32_bf16 v[124:127], v[188:191], v[224:227], v[124:127]
    ds_read_b64_tr_b16 v[206:207], v245 offset:9472
    v_lshlrev_b32 v78, 16, v95
    buffer_load_dwordx4 v81, s[40:43], s26 offen offset:1024 lds
    s_waitcnt lgkmcnt(6)
    v_mfma_f32_16x16x32_bf16 v[128:131], v[192:195], v[212:215], v[128:131]
    ds_read_b64_tr_b16 v[176:177], v244 offset:512
    v_and_b32 v79, 0xffff0000, v95
    s_waitcnt lgkmcnt(5)
    v_mfma_f32_16x16x32_bf16 v[128:131], v[196:199], v[216:219], v[128:131]
    ds_read_b64_tr_b16 v[178:179], v244 offset:1536
    v_lshlrev_b32 v52, 16, v96
    v_mfma_f32_16x16x32_bf16 v[132:135], v[192:195], v[220:223], v[132:135]
    ds_read_b64_tr_b16 v[180:181], v244 offset:8704
    v_and_b32 v53, 0xffff0000, v96
    v_mfma_f32_16x16x32_bf16 v[132:135], v[196:199], v[224:227], v[132:135]
    ds_read_b64_tr_b16 v[182:183], v244 offset:9728
    v_add_f32 v72, v72, v52
    buffer_load_dwordx4 v82, s[40:43], s26 offen offset:2048 lds
    s_waitcnt lgkmcnt(6)
    v_mfma_f32_16x16x32_bf16 v[136:139], v[200:203], v[212:215], v[136:139]
    ds_read_b64_tr_b16 v[184:185], v245 offset:512
    v_add_f32 v73, v73, v53
    s_waitcnt lgkmcnt(5)
    v_mfma_f32_16x16x32_bf16 v[136:139], v[204:207], v[216:219], v[136:139]
    ds_read_b64_tr_b16 v[186:187], v245 offset:1536
    v_lshlrev_b32 v52, 16, v97
    v_mfma_f32_16x16x32_bf16 v[140:143], v[200:203], v[220:223], v[140:143]
    ds_read_b64_tr_b16 v[188:189], v245 offset:8704
    v_and_b32 v53, 0xffff0000, v97
    v_mfma_f32_16x16x32_bf16 v[140:143], v[204:207], v[224:227], v[140:143]
    ds_read_b64_tr_b16 v[190:191], v245 offset:9728
    v_add_f32 v74, v74, v52
    buffer_load_dwordx4 v83, s[40:43], s26 offen offset:3072 lds
    s_add_u32 s26, s26, 128
    s_waitcnt lgkmcnt(6)
    v_mfma_f32_16x16x32_bf16 v[144:147], v[176:179], v[212:215], v[144:147]
    ds_read_b64_tr_b16 v[192:193], v244 offset:768
    v_add_f32 v75, v75, v53
    s_waitcnt lgkmcnt(5)
    v_mfma_f32_16x16x32_bf16 v[144:147], v[180:183], v[216:219], v[144:147]
    ds_read_b64_tr_b16 v[194:195], v244 offset:1792
    v_lshlrev_b32 v52, 16, v98
    v_mfma_f32_16x16x32_bf16 v[148:151], v[176:179], v[220:223], v[148:151]
    ds_read_b64_tr_b16 v[196:197], v244 offset:8960
    v_and_b32 v53, 0xffff0000, v98
    v_mfma_f32_16x16x32_bf16 v[148:151], v[180:183], v[224:227], v[148:151]
    ds_read_b64_tr_b16 v[198:199], v244 offset:9984
    v_add_f32 v76, v76, v52
    s_add_u32 m0, s25, 49152
    s_nop 0
    buffer_load_dwordx4 v246, s[36:39], s24 offen lds
    s_waitcnt lgkmcnt(6)
    v_mfma_f32_16x16x32_bf16 v[152:155], v[184:187], v[212:215], v[152:155]
    ds_read_b64_tr_b16 v[200:201], v245 offset:768
    v_add_f32 v77, v77, v53
    s_waitcnt lgkmcnt(5)
    v_mfma_f32_16x16x32_bf16 v[152:155], v[188:191], v[216:219], v[152:155]
    ds_read_b64_tr_b16 v[202:203], v245 offset:1792
    v_lshlrev_b32 v52, 16, v99
    v_mfma_f32_16x16x32_bf16 v[156:159], v[184:187], v[220:223], v[156:159]
    ds_read_b64_tr_b16 v[204:205], v245 offset:8960
    v_and_b32 v53, 0xffff0000, v99
    v_mfma_f32_16x16x32_bf16 v[156:159], v[188:191], v[224:227], v[156:159]
    ds_read_b64_tr_b16 v[206:207], v245 offset:9984
    v_add_f32 v78, v78, v52
    s_add_u32 m0, s25, 49152
    s_nop 0
    buffer_load_dwordx4 v247, s[36:39], s24 offen offset:1024 lds
    s_add_u32 s24, s24, 524288
    s_waitcnt lgkmcnt(6)
    v_mfma_f32_16x16x32_bf16 v[160:163], v[192:195], v[212:215], v[160:163]
    ds_read_b64_tr_b16 v[176:177], v244 offset:16384
    v_add_f32 v79, v79, v53
    s_waitcnt lgkmcnt(5)
    v_mfma_f32_16x16x32_bf16 v[160:163], v[196:199], v[216:219], v[160:163]
    ds_read_b64_tr_b16 v[178:179], v244 offset:17408
    v_lshlrev_b32 v52, 16, v100
    v_mfma_f32_16x16x32_bf16 v[164:167], v[192:195], v[220:223], v[164:167]
    ds_read_b64_tr_b16 v[180:181], v244 offset:24576
    v_and_b32 v53, 0xffff0000, v100
    v_mfma_f32_16x16x32_bf16 v[164:167], v[196:199], v[224:227], v[164:167]
    ds_read_b64_tr_b16 v[182:183], v244 offset:25600
    v_add_f32 v72, v72, v52
    s_waitcnt vmcnt(9)
    ds_read_b128 v[228:231], v248 offset:32768
    ds_read_b128 v[232:235], v249 offset:32768
    s_waitcnt lgkmcnt(8)
    v_mfma_f32_16x16x32_bf16 v[168:171], v[200:203], v[212:215], v[168:171]
    ds_read_b64_tr_b16 v[184:185], v245 offset:16384
    v_add_f32 v73, v73, v53
    s_waitcnt lgkmcnt(7)
    v_mfma_f32_16x16x32_bf16 v[168:171], v[204:207], v[216:219], v[168:171]
    ds_read_b64_tr_b16 v[186:187], v245 offset:17408
    v_lshlrev_b32 v52, 16, v101
    v_mfma_f32_16x16x32_bf16 v[172:175], v[200:203], v[220:223], v[172:175]
    ds_read_b64_tr_b16 v[188:189], v245 offset:24576
    v_and_b32 v53, 0xffff0000, v101
    v_mfma_f32_16x16x32_bf16 v[172:175], v[204:207], v[224:227], v[172:175]
    ds_read_b64_tr_b16 v[190:191], v245 offset:25600
    v_add_f32 v74, v74, v52
    s_cmp_lg_u32 s3, 0
    s_cbranch_scc1 M_NL2
    v_readfirstlane_b32 s33, v88
    s_nop 0
    s_cmp_lg_u32 s33, 0
    s_cbranch_scc1 M_NSPIN_OK
    v_mov_b32 v210, 0
    s_mov_b32 s73, 20000
M_NSPIN:
    global_load_dword v88, v210, s[66:67] sc1
    s_waitcnt vmcnt(0)
    v_readfirstlane_b32 s33, v88
    s_nop 0
    s_cmp_lg_u32 s33, 0
    s_cbranch_scc1 M_NSPIN_OK
    s_sub_u32 s73, s73, 1
    s_cmp_lg_u32 s73, 0
    s_cbranch_scc1 M_NSPIN
M_NSPIN_OK:
    v_mov_b32 v210, 147488
    ds_write_b32 v210, v88
    s_waitcnt lgkmcnt(0)
M_NL2:
    ds_read_b128 v[236:239], v248 offset:34816
    ds_read_b128 v[240:243], v249 offset:34816
    s_waitcnt vmcnt(7)
    s_barrier
    s_waitcnt lgkmcnt(7)
    v_mfma_f32_16x16x32_bf16 v[112:115], v[176:179], v[228:231], v[112:115]
    ds_read_b64_tr_b16 v[192:193], v244 offset:16640
    v_add_f32 v75, v75, v53
    s_waitcnt lgkmcnt(7)
    v_mfma_f32_16x16x32_bf16 v[112:115], v[180:183], v[232:235], v[112:115]
    ds_read_b64_tr_b16 v[194:195], v244 offset:17664
    v_lshlrev_b32 v52, 16, v102
    s_waitcnt lgkmcnt(3)
    v_mfma_f32_16x16x32_bf16 v[116:119], v[176:179], v[236:239], v[116:119]
    ds_read_b64_tr_b16 v[196:197], v244 offset:24832
    v_and_b32 v53, 0xffff0000, v102
    s_waitcnt lgkmcnt(3)
    v_mfma_f32_16x16x32_bf16 v[116:119], v[180:183], v[240:243], v[116:119]
    ds_read_b64_tr_b16 v[198:199], v244 offset:25856
    v_add_f32 v76, v76, v52
    s_add_u32 m0, s100, 32768
    s_nop 0
    buffer_load_dwordx4 v80, s[40:43], s26 offen offset:0 lds
    v_mfma_f32_16x16x32_bf16 v[120:123], v[184:187], v[228:231], v[120:123]
    ds_read_b64_tr_b16 v[200:201], v245 offset:16640
    v_add_f32 v77, v77, v53
    v_mfma_f32_16x16x32_bf16 v[120:123], v[188:191], v[232:235], v[120:123]
    ds_read_b64_tr_b16 v[202:203], v245 offset:17664
    v_lshlrev_b32 v52, 16, v103
    v_mfma_f32_16x16x32_bf16 v[124:127], v[184:187], v[236:239], v[124:127]
    ds_read_b64_tr_b16 v[204:205], v245 offset:24832
    v_and_b32 v53, 0xffff0000, v103
    v_mfma_f32_16x16x32_bf16 v[124:127], v[188:191], v[240:243], v[124:127]
    ds_read_b64_tr_b16 v[206:207], v245 offset:25856
    v_add_f32 v78, v78, v52
    buffer_load_dwordx4 v81, s[40:43], s26 offen offset:1024 lds
    s_waitcnt lgkmcnt(6)
    v_mfma_f32_16x16x32_bf16 v[128:131], v[192:195], v[228:231], v[128:131]
    ds_read_b64_tr_b16 v[176:177], v244 offset:16896
    v_add_f32 v79, v79, v53
    s_waitcnt lgkmcnt(5)
    v_mfma_f32_16x16x32_bf16 v[128:131], v[196:199], v[232:235], v[128:131]
    ds_read_b64_tr_b16 v[178:179], v244 offset:17920
    v_lshlrev_b32 v52, 16, v104
    v_mfma_f32_16x16x32_bf16 v[132:135], v[192:195], v[236:239], v[132:135]
    ds_read_b64_tr_b16 v[180:181], v244 offset:25088
    v_and_b32 v53, 0xffff0000, v104
    v_mfma_f32_16x16x32_bf16 v[132:135], v[196:199], v[240:243], v[132:135]
    ds_read_b64_tr_b16 v[182:183], v244 offset:26112
    v_add_f32 v72, v72, v52
    buffer_load_dwordx4 v82, s[40:43], s26 offen offset:2048 lds
    s_waitcnt lgkmcnt(6)
    v_mfma_f32_16x16x32_bf16 v[136:139], v[200:203], v[228:231], v[136:139]
    ds_read_b64_tr_b16 v[184:185], v245 offset:16896
    v_add_f32 v73, v73, v53
    s_waitcnt lgkmcnt(5)
    v_mfma_f32_16x16x32_bf16 v[136:139], v[204:207], v[232:235], v[136:139]
    ds_read_b64_tr_b16 v[186:187], v245 offset:17920
    v_lshlrev_b32 v52, 16, v105
    v_mfma_f32_16x16x32_bf16 v[140:143], v[200:203], v[236:239], v[140:143]
    ds_read_b64_tr_b16 v[188:189], v245 offset:25088
    v_and_b32 v53, 0xffff0000, v105
    v_mfma_f32_16x16x32_bf16 v[140:143], v[204:207], v[240:243], v[140:143]
    ds_read_b64_tr_b16 v[190:191], v245 offset:26112
    v_add_f32 v74, v74, v52
    buffer_load_dwordx4 v83, s[40:43], s26 offen offset:3072 lds
    s_add_u32 s26, s26, 128
    s_waitcnt lgkmcnt(6)
    v_mfma_f32_16x16x32_bf16 v[144:147], v[176:179], v[228:231], v[144:147]
    ds_read_b64_tr_b16 v[192:193], v244 offset:17152
    v_add_f32 v75, v75, v53
    s_waitcnt lgkmcnt(5)
    v_mfma_f32_16x16x32_bf16 v[144:147], v[180:183], v[232:235], v[144:147]
    ds_read_b64_tr_b16 v[194:195], v244 offset:18176
    v_lshlrev_b32 v52, 16, v106
    v_mfma_f32_16x16x32_bf16 v[148:151], v[176:179], v[236:239], v[148:151]
    ds_read_b64_tr_b16 v[196:197], v244 offset:25344
    v_and_b32 v53, 0xffff0000, v106
    v_mfma_f32_16x16x32_bf16 v[148:151], v[180:183], v[240:243], v[148:151]
    ds_read_b64_tr_b16 v[198:199], v244 offset:26368
    v_add_f32 v76, v76, v52
    s_add_u32 m0, s25, 0
    s_nop 0
    buffer_load_dwordx4 v246, s[36:39], s24 offen lds
    s_waitcnt lgkmcnt(6)
    v_mfma_f32_16x16x32_bf16 v[152:155], v[184:187], v[228:231], v[152:155]
    ds_read_b64_tr_b16 v[200:201], v245 offset:17152
    v_add_f32 v77, v77, v53
    s_waitcnt lgkmcnt(5)
    v_mfma_f32_16x16x32_bf16 v[152:155], v[188:191], v[232:235], v[152:155]
    ds_read_b64_tr_b16 v[202:203], v245 offset:18176
    v_lshlrev_b32 v52, 16, v107
    v_mfma_f32_16x16x32_bf16 v[156:159], v[184:187], v[236:239], v[156:159]
    ds_read_b64_tr_b16 v[204:205], v245 offset:25344
    v_and_b32 v53, 0xffff0000, v107
    v_mfma_f32_16x16x32_bf16 v[156:159], v[188:191], v[240:243], v[156:159]
    ds_read_b64_tr_b16 v[206:207], v245 offset:26368
    v_add_f32 v78, v78, v52
    s_add_u32 m0, s25, 0
    s_nop 0
    buffer_load_dwordx4 v247, s[36:39], s24 offen offset:1024 lds
    s_add_u32 s24, s24, 524288
    s_waitcnt lgkmcnt(6)
    v_mfma_f32_16x16x32_bf16 v[160:163], v[192:195], v[228:231], v[160:163]
    ds_read_b64_tr_b16 v[176:177], v244 offset:32768
    v_add_f32 v79, v79, v53
    s_waitcnt lgkmcnt(5)
    v_mfma_f32_16x16x32_bf16 v[160:163], v[196:199], v[232:235], v[160:163]
    ds_read_b64_tr_b16 v[178:179], v244 offset:33792
    v_lshlrev_b32 v49, 5, v0
    v_mfma_f32_16x16x32_bf16 v[164:167], v[192:195], v[236:239], v[164:167]
    ds_read_b64_tr_b16 v[180:181], v244 offset:40960
    v_add_u32 v49, 131072, v49
    v_mfma_f32_16x16x32_bf16 v[164:167], v[196:199], v[240:243], v[164:167]
    ds_read_b64_tr_b16 v[182:183], v244 offset:41984
    ds_write_b128 v49, v[72:75]
    v_mov_b32 v210, 147488
    ds_read_b32 v88, v210
    s_waitcnt vmcnt(8)
    ds_read_b128 v[212:215], v248 offset:0
    ds_read_b128 v[216:219], v249 offset:0
    s_waitcnt lgkmcnt(10)
    v_mfma_f32_16x16x32_bf16 v[168:171], v[200:203], v[228:231], v[168:171]
    ds_read_b64_tr_b16 v[184:185], v245 offset:32768
    ds_write_b128 v49, v[76:79] offset:16
    s_waitcnt lgkmcnt(10)
    v_mfma_f32_16x16x32_bf16 v[168:171], v[204:207], v[232:235], v[168:171]
    ds_read_b64_tr_b16 v[186:187], v245 offset:33792
    v_mfma_f32_16x16x32_bf16 v[172:175], v[200:203], v[236:239], v[172:175]
    ds_read_b64_tr_b16 v[188:189], v245 offset:40960
    v_mfma_f32_16x16x32_bf16 v[172:175], v[204:207], v[240:243], v[172:175]
    ds_read_b64_tr_b16 v[190:191], v245 offset:41984
    s_waitcnt lgkmcnt(7)
    v_readfirstlane_b32 s33, v88
    ds_read_b128 v[220:223], v248 offset:2048
    ds_read_b128 v[224:227], v249 offset:2048
    s_waitcnt vmcnt(6)
    s_waitcnt lgkmcnt(5)
    s_barrier
    v_mfma_f32_16x16x32_bf16 v[112:115], v[176:179], v[212:215], v[112:115]
    ds_read_b64_tr_b16 v[192:193], v244 offset:33024
    v_lshrrev_b32 v96, 3, v1
    v_mfma_f32_16x16x32_bf16 v[112:115], v[180:183], v[216:219], v[112:115]
    ds_read_b64_tr_b16 v[194:195], v244 offset:34048
    v_lshlrev_b32 v96, 9, v96
    s_waitcnt lgkmcnt(3)
    v_mfma_f32_16x16x32_bf16 v[116:119], v[176:179], v[220:223], v[116:119]
    ds_read_b64_tr_b16 v[196:197], v244 offset:41216
    v_and_b32 v97, 7, v1
    s_waitcnt lgkmcnt(3)
    v_mfma_f32_16x16x32_bf16 v[116:119], v[180:183], v[224:227], v[116:119]
    ds_read_b64_tr_b16 v[198:199], v244 offset:42240
    v_lshl_add_u32 v96, v97, 3, v96
    s_add_u32 m0, s100, 0
    s_nop 0
    buffer_load_dwordx4 v80, s[40:43], s26 offen offset:0 lds
    v_mfma_f32_16x16x32_bf16 v[120:123], v[184:187], v[212:215], v[120:123]
    ds_read_b64_tr_b16 v[200:201], v245 offset:33024
    s_lshl_b32 s60, s3, 6
    v_mfma_f32_16x16x32_bf16 v[120:123], v[188:191], v[216:219], v[120:123]
    ds_read_b64_tr_b16 v[202:203], v245 offset:34048
    s_add_u32 s60, s60, 131072
    v_mfma_f32_16x16x32_bf16 v[124:127], v[184:187], v[220:223], v[124:127]
    ds_read_b64_tr_b16 v[204:205], v245 offset:41216
    v_add_u32 v96, s60, v96
    v_mfma_f32_16x16x32_bf16 v[124:127], v[188:191], v[224:227], v[124:127]
    ds_read_b64_tr_b16 v[206:207], v245 offset:42240
    ds_read_b64 v[92:93], v96
    buffer_load_dwordx4 v81, s[40:43], s26 offen offset:1024 lds
    s_waitcnt lgkmcnt(7)
    v_mfma_f32_16x16x32_bf16 v[128:131], v[192:195], v[212:215], v[128:131]
    ds_read_b64_tr_b16 v[176:177], v244 offset:33280
    ds_read_b64 v[100:101], v96 offset:4096
    s_waitcnt lgkmcnt(7)
    v_mfma_f32_16x16x32_bf16 v[128:131], v[196:199], v[216:219], v[128:131]
    ds_read_b64_tr_b16 v[178:179], v244 offset:34304
    s_nop 0
    v_mfma_f32_16x16x32_bf16 v[132:135], v[192:195], v[220:223], v[132:135]
    ds_read_b64_tr_b16 v[180:181], v244 offset:41472
    s_nop 0
    v_mfma_f32_16x16x32_bf16 v[132:135], v[196:199], v[224:227], v[132:135]
    ds_read_b64_tr_b16 v[182:183], v244 offset:42496
    s_nop 0
    buffer_load_dwordx4 v82, s[40:43], s26 offen offset:2048 lds
    s_waitcnt lgkmcnt(8)
    v_mfma_f32_16x16x32_bf16 v[136:139], v[200:203], v[212:215], v[136:139]
    ds_read_b64_tr_b16 v[184:185], v245 offset:33280
    s_nop 0
    s_waitcnt lgkmcnt(7)
    v_mfma_f32_16x16x32_bf16 v[136:139], v[204:207], v[216:219], v[136:139]
    ds_read_b64_tr_b16 v[186:187], v245 offset:34304
    ds_read_b64 v[102:103], v96 offset:8192
    v_mfma_f32_16x16x32_bf16 v[140:143], v[200:203], v[220:223], v[140:143]
    ds_read_b64_tr_b16 v[188:189], v245 offset:41472
    ds_read_b64 v[104:105], v96 offset:12288
    v_mfma_f32_16x16x32_bf16 v[140:143], v[204:207], v[224:227], v[140:143]
    ds_read_b64_tr_b16 v[190:191], v245 offset:42496
    s_lshl_b32 s60, s20, 3
    buffer_load_dwordx4 v83, s[40:43], s26 offen offset:3072 lds
    s_add_u32 s26, s26, 128
    s_waitcnt lgkmcnt(8)
    v_mfma_f32_16x16x32_bf16 v[144:147], v[176:179], v[212:215], v[144:147]
    ds_read_b64_tr_b16 v[192:193], v244 offset:33536
    s_add_u32 s60, s60, s21
    s_waitcnt lgkmcnt(7)
    v_mfma_f32_16x16x32_bf16 v[144:147], v[180:183], v[216:219], v[144:147]
    ds_read_b64_tr_b16 v[194:195], v244 offset:34560
    s_lshl_b32 s60, s60, 3
    v_mfma_f32_16x16x32_bf16 v[148:151], v[176:179], v[220:223], v[148:151]
    ds_read_b64_tr_b16 v[196:197], v244 offset:41728
    s_add_u32 s60, s60, s3
    v_mfma_f32_16x16x32_bf16 v[148:151], v[180:183], v[224:227], v[148:151]
    ds_read_b64_tr_b16 v[198:199], v244 offset:42752
    s_lshl_b32 s60, s60, 7
    s_add_u32 m0, s25, 16384
    s_nop 0
    buffer_load_dwordx4 v246, s[36:39], s24 offen lds
    s_waitcnt lgkmcnt(8)
    v_mfma_f32_16x16x32_bf16 v[152:155], v[184:187], v[212:215], v[152:155]
    ds_read_b64_tr_b16 v[200:201], v245 offset:33536
    s_add_u32 s60, s60, 5439488
    s_waitcnt lgkmcnt(5)
    v_mfma_f32_16x16x32_bf16 v[152:155], v[188:191], v[216:219], v[152:155]
    ds_read_b64_tr_b16 v[202:203], v245 offset:34560
    v_lshlrev_b32 v97, 4, v97
    v_mfma_f32_16x16x32_bf16 v[156:159], v[184:187], v[220:223], v[156:159]
    ds_read_b64_tr_b16 v[204:205], v245 offset:41728
    v_add_u32 v97, s60, v97
    v_mfma_f32_16x16x32_bf16 v[156:159], v[188:191], v[224:227], v[156:159]
    ds_read_b64_tr_b16 v[206:207], v245 offset:42752
    s_lshl_b32 s60, s65, 3
    s_add_u32 m0, s25, 16384
    s_nop 0
    buffer_load_dwordx4 v247, s[36:39], s24 offen offset:1024 lds
    s_add_u32 s24, s24, 524288
    s_waitcnt lgkmcnt(6)
    v_mfma_f32_16x16x32_bf16 v[160:163], v[192:195], v[212:215], v[160:163]
    ds_read_b64_tr_b16 v[176:177], v244 offset:49152
    s_add_u32 s60, s60, s3
    s_waitcnt lgkmcnt(5)
    v_mfma_f32_16x16x32_bf16 v[160:163], v[196:199], v[216:219], v[160:163]
    ds_read_b64_tr_b16 v[178:179], v244 offset:50176
    s_lshl_b32 s60, s60, 3
    v_mfma_f32_16x16x32_bf16 v[164:167], v[192:195], v[220:223], v[164:167]
    ds_read_b64_tr_b16 v[180:181], v244 offset:57344
    s_add_u32 s60, s60, 5373952
    v_mfma_f32_16x16x32_bf16 v[164:167], v[196:199], v[224:227], v[164:167]
    ds_read_b64_tr_b16 v[182:183], v244 offset:58368
    v_mov_b32 v98, s60
    s_waitcnt vmcnt(8)
    ds_read_b128 v[228:231], v248 offset:32768
    ds_read_b128 v[232:235], v249 offset:32768
    s_waitcnt lgkmcnt(8)
    v_mfma_f32_16x16x32_bf16 v[168:171], v[200:203], v[212:215], v[168:171]
    ds_read_b64_tr_b16 v[184:185], v245 offset:49152
    v_mov_b32 v71, s33
    s_waitcnt lgkmcnt(7)
    v_mfma_f32_16x16x32_bf16 v[168:171], v[204:207], v[216:219], v[168:171]
    ds_read_b64_tr_b16 v[186:187], v245 offset:50176
    s_mov_b64 exec, 1
    global_store_dwordx2 v98, v[70:71], s[18:19] sc1
    s_mov_b64 exec, -1
    v_mfma_f32_16x16x32_bf16 v[172:175], v[200:203], v[220:223], v[172:175]
    ds_read_b64_tr_b16 v[188:189], v245 offset:57344
    v_mfma_f32_16x16x32_bf16 v[172:175], v[204:207], v[224:227], v[172:175]
    ds_read_b64_tr_b16 v[190:191], v245 offset:58368
    v_add_f32 v92, v92, v100
    ds_read_b128 v[236:239], v248 offset:34816
    ds_read_b128 v[240:243], v249 offset:34816
    s_waitcnt vmcnt(7)
    s_barrier
    s_waitcnt lgkmcnt(7)
    v_mfma_f32_16x16x32_bf16 v[112:115], v[176:179], v[228:231], v[112:115]
    ds_read_b64_tr_b16 v[192:193], v244 offset:49408
    v_add_f32 v93, v93, v101
    s_waitcnt lgkmcnt(7)
    v_mfma_f32_16x16x32_bf16 v[112:115], v[180:183], v[232:235], v[112:115]
    ds_read_b64_tr_b16 v[194:195], v244 offset:50432
    v_add_f32 v102, v102, v104
    s_waitcnt lgkmcnt(3)
    v_mfma_f32_16x16x32_bf16 v[116:119], v[176:179], v[236:239], v[116:119]
    ds_read_b64_tr_b16 v[196:197], v244 offset:57600
    v_add_f32 v103, v103, v105
    s_waitcnt lgkmcnt(3)
    v_mfma_f32_16x16x32_bf16 v[116:119], v[180:183], v[240:243], v[116:119]
    ds_read_b64_tr_b16 v[198:199], v244 offset:58624
    v_add_f32 v92, v92, v102
    s_add_u32 m0, s100, 32768
    s_nop 0
    buffer_load_dwordx4 v80, s[40:43], s26 offen offset:0 lds
    v_mfma_f32_16x16x32_bf16 v[120:123], v[184:187], v[228:231], v[120:123]
    ds_read_b64_tr_b16 v[200:201], v245 offset:49408
    v_add_f32 v94, v93, v103
    v_mfma_f32_16x16x32_bf16 v[120:123], v[188:191], v[232:235], v[120:123]
    ds_read_b64_tr_b16 v[202:203], v245 offset:50432
    v_add_f32_dpp v92, v92, v92 row_ror:8 row_mask:0xf bank_mask:0xf
    v_mfma_f32_16x16x32_bf16 v[124:127], v[184:187], v[236:239], v[124:127]
    ds_read_b64_tr_b16 v[204:205], v245 offset:57600
    v_add_f32_dpp v94, v94, v94 row_ror:8 row_mask:0xf bank_mask:0xf
    v_mfma_f32_16x16x32_bf16 v[124:127], v[188:191], v[240:243], v[124:127]
    ds_read_b64_tr_b16 v[206:207], v245 offset:58624
    v_mov_b32 v93, v92
    buffer_load_dwordx4 v81, s[40:43], s26 offen offset:1024 lds
    s_waitcnt lgkmcnt(6)
    v_mfma_f32_16x16x32_bf16 v[128:131], v[192:195], v[228:231], v[128:131]
    ds_read_b64_tr_b16 v[176:177], v244 offset:49664
    v_mov_b32 v95, v94
    s_waitcnt lgkmcnt(5)
    v_mfma_f32_16x16x32_bf16 v[128:131], v[196:199], v[232:235], v[128:131]
    ds_read_b64_tr_b16 v[178:179], v244 offset:50688
    v_permlane16_swap_b32 v92, v93
    v_mfma_f32_16x16x32_bf16 v[132:135], v[192:195], v[236:239], v[132:135]
    ds_read_b64_tr_b16 v[180:181], v244 offset:57856
    v_permlane16_swap_b32 v94, v95
    v_mfma_f32_16x16x32_bf16 v[132:135], v[196:199], v[240:243], v[132:135]
    ds_read_b64_tr_b16 v[182:183], v244 offset:58880
    v_add_f32 v92, v92, v93
    buffer_load_dwordx4 v82, s[40:43], s26 offen offset:2048 lds
    s_waitcnt lgkmcnt(6)
    v_mfma_f32_16x16x32_bf16 v[136:139], v[200:203], v[228:231], v[136:139]
    ds_read_b64_tr_b16 v[184:185], v245 offset:49664
    v_add_f32 v94, v94, v95
    s_waitcnt lgkmcnt(5)
    v_mfma_f32_16x16x32_bf16 v[136:139], v[204:207], v[232:235], v[136:139]
    ds_read_b64_tr_b16 v[186:187], v245 offset:50688
    v_mov_b32 v93, v92
    v_mfma_f32_16x16x32_bf16 v[140:143], v[200:203], v[236:239], v[140:143]
    ds_read_b64_tr_b16 v[188:189], v245 offset:57856
    v_mov_b32 v95, v94
    v_mfma_f32_16x16x32_bf16 v[140:143], v[204:207], v[240:243], v[140:143]
    ds_read_b64_tr_b16 v[190:191], v245 offset:58880
    v_permlane32_swap_b32 v92, v93
    buffer_load_dwordx4 v83, s[40:43], s26 offen offset:3072 lds
    s_add_u32 s26, s26, 128
    s_waitcnt lgkmcnt(6)
    v_mfma_f32_16x16x32_bf16 v[144:147], v[176:179], v[228:231], v[144:147]
    ds_read_b64_tr_b16 v[192:193], v244 offset:49920
    v_permlane32_swap_b32 v94, v95
    s_waitcnt lgkmcnt(5)
    v_mfma_f32_16x16x32_bf16 v[144:147], v[180:183], v[232:235], v[144:147]
    ds_read_b64_tr_b16 v[194:195], v244 offset:50944
    v_add_f32 v92, v92, v93
    v_mfma_f32_16x16x32_bf16 v[148:151], v[176:179], v[236:239], v[148:151]
    ds_read_b64_tr_b16 v[196:197], v244 offset:58112
    v_add_f32 v94, v94, v95
    v_mfma_f32_16x16x32_bf16 v[148:151], v[180:183], v[240:243], v[148:151]
    ds_read_b64_tr_b16 v[198:199], v244 offset:59136
    v_mov_b32 v93, s33
    s_add_u32 m0, s25, 32768
    s_nop 0
    buffer_load_dwordx4 v246, s[36:39], s24 offen lds
    s_waitcnt lgkmcnt(6)
    v_mfma_f32_16x16x32_bf16 v[152:155], v[184:187], v[228:231], v[152:155]
    ds_read_b64_tr_b16 v[200:201], v245 offset:49920
    v_mov_b32 v95, s33
    s_waitcnt lgkmcnt(5)
    v_mfma_f32_16x16x32_bf16 v[152:155], v[188:191], v[232:235], v[152:155]
    ds_read_b64_tr_b16 v[202:203], v245 offset:50944
    s_mov_b64 exec, 0xff
    global_store_dwordx4 v97, v[92:95], s[18:19] sc1
    s_mov_b64 exec, -1
    v_mfma_f32_16x16x32_bf16 v[156:159], v[184:187], v[236:239], v[156:159]
    ds_read_b64_tr_b16 v[204:205], v245 offset:58112
    v_mfma_f32_16x16x32_bf16 v[156:159], v[188:191], v[240:243], v[156:159]
    ds_read_b64_tr_b16 v[206:207], v245 offset:59136
    s_add_u32 m0, s25, 32768
    s_nop 0
    buffer_load_dwordx4 v247, s[36:39], s24 offen offset:1024 lds
    s_add_u32 s24, s24, 524288
    s_waitcnt lgkmcnt(6)
    v_mfma_f32_16x16x32_bf16 v[160:163], v[192:195], v[228:231], v[160:163]
    ds_read_b64_tr_b16 v[176:177], v244 offset:0
    s_waitcnt lgkmcnt(5)
    v_mfma_f32_16x16x32_bf16 v[160:163], v[196:199], v[232:235], v[160:163]
    ds_read_b64_tr_b16 v[178:179], v244 offset:1024
    v_mfma_f32_16x16x32_bf16 v[164:167], v[192:195], v[236:239], v[164:167]
    ds_read_b64_tr_b16 v[180:181], v244 offset:8192
    v_mfma_f32_16x16x32_bf16 v[164:167], v[196:199], v[240:243], v[164:167]
    ds_read_b64_tr_b16 v[182:183], v244 offset:9216
    s_waitcnt vmcnt(10)
    ds_read_b128 v[212:215], v248 offset:0
    ds_read_b128 v[216:219], v249 offset:0
    s_waitcnt lgkmcnt(8)
    v_mfma_f32_16x16x32_bf16 v[168:171], v[200:203], v[228:231], v[168:171]
    ds_read_b64_tr_b16 v[184:185], v245 offset:0
    s_waitcnt lgkmcnt(7)
    v_mfma_f32_16x16x32_bf16 v[168:171], v[204:207], v[232:235], v[168:171]
    ds_read_b64_tr_b16 v[186:187], v245 offset:1024
    v_mfma_f32_16x16x32_bf16 v[172:175], v[200:203], v[236:239], v[172:175]
    ds_read_b64_tr_b16 v[188:189], v245 offset:8192
    v_mfma_f32_16x16x32_bf16 v[172:175], v[204:207], v[240:243], v[172:175]
    ds_read_b64_tr_b16 v[190:191], v245 offset:9216
    ds_read_b128 v[220:223], v248 offset:2048
    ds_read_b128 v[224:227], v249 offset:2048
    s_waitcnt vmcnt(8)
    s_barrier
    s_waitcnt lgkmcnt(7)
    v_mfma_f32_16x16x32_bf16 v[112:115], v[176:179], v[212:215], v[112:115]
    ds_read_b64_tr_b16 v[192:193], v244 offset:256
    s_waitcnt lgkmcnt(7)
    v_mfma_f32_16x16x32_bf16 v[112:115], v[180:183], v[216:219], v[112:115]
    ds_read_b64_tr_b16 v[194:195], v244 offset:1280
    s_waitcnt lgkmcnt(3)
    v_mfma_f32_16x16x32_bf16 v[116:119], v[176:179], v[220:223], v[116:119]
    ds_read_b64_tr_b16 v[196:197], v244 offset:8448
    s_waitcnt lgkmcnt(3)
    v_mfma_f32_16x16x32_bf16 v[116:119], v[180:183], v[224:227], v[116:119]
    ds_read_b64_tr_b16 v[198:199], v244 offset:9472
    s_add_u32 m0, s100, 0
    s_nop 0
    buffer_load_dwordx4 v80, s[40:43], s26 offen offset:0 lds
    v_mfma_f32_16x16x32_bf16 v[120:123], v[184:187], v[212:215], v[120:123]
    ds_read_b64_tr_b16 v[200:201], v245 offset:256
    v_mfma_f32_16x16x32_bf16 v[120:123], v[188:191], v[216:219], v[120:123]
    ds_read_b64_tr_b16 v[202:203], v245 offset:1280
    v_mfma_f32_16x16x32_bf16 v[124:127], v[184:187], v[220:223], v[124:127]
    ds_read_b64_tr_b16 v[204:205], v245 offset:8448
    v_mfma_f32_16x16x32_bf16 v[124:127], v[188:191], v[224:227], v[124:127]
    ds_read_b64_tr_b16 v[206:207], v245 offset:9472
    buffer_load_dwordx4 v81, s[40:43], s26 offen offset:1024 lds
    s_waitcnt lgkmcnt(6)
    v_mfma_f32_16x16x32_bf16 v[128:131], v[192:195], v[212:215], v[128:131]
    ds_read_b64_tr_b16 v[176:177], v244 offset:512
    s_waitcnt lgkmcnt(5)
    v_mfma_f32_16x16x32_bf16 v[128:131], v[196:199], v[216:219], v[128:131]
    ds_read_b64_tr_b16 v[178:179], v244 offset:1536
    v_mfma_f32_16x16x32_bf16 v[132:135], v[192:195], v[220:223], v[132:135]
    ds_read_b64_tr_b16 v[180:181], v244 offset:8704
    v_mfma_f32_16x16x32_bf16 v[132:135], v[196:199], v[224:227], v[132:135]
    ds_read_b64_tr_b16 v[182:183], v244 offset:9728
    buffer_load_dwordx4 v82, s[40:43], s26 offen offset:2048 lds
    s_waitcnt lgkmcnt(6)
    v_mfma_f32_16x16x32_bf16 v[136:139], v[200:203], v[212:215], v[136:139]
    ds_read_b64_tr_b16 v[184:185], v245 offset:512
    s_waitcnt lgkmcnt(5)
    v_mfma_f32_16x16x32_bf16 v[136:139], v[204:207], v[216:219], v[136:139]
    ds_read_b64_tr_b16 v[186:187], v245 offset:1536
    v_mfma_f32_16x16x32_bf16 v[140:143], v[200:203], v[220:223], v[140:143]
    ds_read_b64_tr_b16 v[188:189], v245 offset:8704
    v_mfma_f32_16x16x32_bf16 v[140:143], v[204:207], v[224:227], v[140:143]
    ds_read_b64_tr_b16 v[190:191], v245 offset:9728
    buffer_load_dwordx4 v83, s[40:43], s26 offen offset:3072 lds
    s_add_u32 s26, s26, 128
    s_waitcnt lgkmcnt(6)
    v_mfma_f32_16x16x32_bf16 v[144:147], v[176:179], v[212:215], v[144:147]
    ds_read_b64_tr_b16 v[192:193], v244 offset:768
    s_waitcnt lgkmcnt(5)
    v_mfma_f32_16x16x32_bf16 v[144:147], v[180:183], v[216:219], v[144:147]
    ds_read_b64_tr_b16 v[194:195], v244 offset:1792
    v_mfma_f32_16x16x32_bf16 v[148:151], v[176:179], v[220:223], v[148:151]
    ds_read_b64_tr_b16 v[196:197], v244 offset:8960
    v_mfma_f32_16x16x32_bf16 v[148:151], v[180:183], v[224:227], v[148:151]
    ds_read_b64_tr_b16 v[198:199], v244 offset:9984
    s_add_u32 m0, s25, 49152
    s_nop 0
    buffer_load_dwordx4 v246, s[36:39], s24 offen lds
    s_waitcnt lgkmcnt(6)
    v_mfma_f32_16x16x32_bf16 v[152:155], v[184:187], v[212:215], v[152:155]
    ds_read_b64_tr_b16 v[200:201], v245 offset:768
    s_waitcnt lgkmcnt(5)
    v_mfma_f32_16x16x32_bf16 v[152:155], v[188:191], v[216:219], v[152:155]
    ds_read_b64_tr_b16 v[202:203], v245 offset:1792
    v_mfma_f32_16x16x32_bf16 v[156:159], v[184:187], v[220:223], v[156:159]
    ds_read_b64_tr_b16 v[204:205], v245 offset:8960
    v_mfma_f32_16x16x32_bf16 v[156:159], v[188:191], v[224:227], v[156:159]
    ds_read_b64_tr_b16 v[206:207], v245 offset:9984
    s_add_u32 m0, s25, 49152
    s_nop 0
    buffer_load_dwordx4 v247, s[36:39], s24 offen offset:1024 lds
    s_add_u32 s24, s24, 524288
    s_waitcnt lgkmcnt(6)
    v_mfma_f32_16x16x32_bf16 v[160:163], v[192:195], v[212:215], v[160:163]
    ds_read_b64_tr_b16 v[176:177], v244 offset:16384
    s_waitcnt lgkmcnt(5)
    v_mfma_f32_16x16x32_bf16 v[160:163], v[196:199], v[216:219], v[160:163]
    ds_read_b64_tr_b16 v[178:179], v244 offset:17408
    v_mfma_f32_16x16x32_bf16 v[164:167], v[192:195], v[220:223], v[164:167]
    ds_read_b64_tr_b16 v[180:181], v244 offset:24576
    v_mfma_f32_16x16x32_bf16 v[164:167], v[196:199], v[224:227], v[164:167]
    ds_read_b64_tr_b16 v[182:183], v244 offset:25600
    s_waitcnt vmcnt(9)
    ds_read_b128 v[228:231], v248 offset:32768
    ds_read_b128 v[232:235], v249 offset:32768
    s_waitcnt lgkmcnt(8)
    v_mfma_f32_16x16x32_bf16 v[168:171], v[200:203], v[212:215], v[168:171]
    ds_read_b64_tr_b16 v[184:185], v245 offset:16384
    s_waitcnt lgkmcnt(7)
    v_mfma_f32_16x16x32_bf16 v[168:171], v[204:207], v[216:219], v[168:171]
    ds_read_b64_tr_b16 v[186:187], v245 offset:17408
    v_mfma_f32_16x16x32_bf16 v[172:175], v[200:203], v[220:223], v[172:175]
    ds_read_b64_tr_b16 v[188:189], v245 offset:24576
    v_mfma_f32_16x16x32_bf16 v[172:175], v[204:207], v[224:227], v[172:175]
    ds_read_b64_tr_b16 v[190:191], v245 offset:25600
    ds_read_b128 v[236:239], v248 offset:34816
    ds_read_b128 v[240:243], v249 offset:34816
    s_waitcnt vmcnt(6)
    s_barrier
    s_waitcnt lgkmcnt(7)
    v_mfma_f32_16x16x32_bf16 v[112:115], v[176:179], v[228:231], v[112:115]
    ds_read_b64_tr_b16 v[192:193], v244 offset:16640
    s_waitcnt lgkmcnt(7)
    v_mfma_f32_16x16x32_bf16 v[112:115], v[180:183], v[232:235], v[112:115]
    ds_read_b64_tr_b16 v[194:195], v244 offset:17664
    s_waitcnt lgkmcnt(3)
    v_mfma_f32_16x16x32_bf16 v[116:119], v[176:179], v[236:239], v[116:119]
    ds_read_b64_tr_b16 v[196:197], v244 offset:24832
    s_waitcnt lgkmcnt(3)
    v_mfma_f32_16x16x32_bf16 v[116:119], v[180:183], v[240:243], v[116:119]
    ds_read_b64_tr_b16 v[198:199], v244 offset:25856
    s_add_u32 m0, s100, 32768
    s_nop 0
    buffer_load_dwordx4 v80, s[40:43], s26 offen offset:0 lds
    v_mfma_f32_16x16x32_bf16 v[120:123], v[184:187], v[228:231], v[120:123]
    ds_read_b64_tr_b16 v[200:201], v245 offset:16640
    v_mfma_f32_16x16x32_bf16 v[120:123], v[188:191], v[232:235], v[120:123]
    ds_read_b64_tr_b16 v[202:203], v245 offset:17664
    v_mfma_f32_16x16x32_bf16 v[124:127], v[184:187], v[236:239], v[124:127]
    ds_read_b64_tr_b16 v[204:205], v245 offset:24832
    v_mfma_f32_16x16x32_bf16 v[124:127], v[188:191], v[240:243], v[124:127]
    ds_read_b64_tr_b16 v[206:207], v245 offset:25856
    buffer_load_dwordx4 v81, s[40:43], s26 offen offset:1024 lds
    s_waitcnt lgkmcnt(6)
    v_mfma_f32_16x16x32_bf16 v[128:131], v[192:195], v[228:231], v[128:131]
    ds_read_b64_tr_b16 v[176:177], v244 offset:16896
    s_waitcnt lgkmcnt(5)
    v_mfma_f32_16x16x32_bf16 v[128:131], v[196:199], v[232:235], v[128:131]
    ds_read_b64_tr_b16 v[178:179], v244 offset:17920
    v_mfma_f32_16x16x32_bf16 v[132:135], v[192:195], v[236:239], v[132:135]
    ds_read_b64_tr_b16 v[180:181], v244 offset:25088
    v_mfma_f32_16x16x32_bf16 v[132:135], v[196:199], v[240:243], v[132:135]
    ds_read_b64_tr_b16 v[182:183], v244 offset:26112
    buffer_load_dwordx4 v82, s[40:43], s26 offen offset:2048 lds
    s_waitcnt lgkmcnt(6)
    v_mfma_f32_16x16x32_bf16 v[136:139], v[200:203], v[228:231], v[136:139]
    ds_read_b64_tr_b16 v[184:185], v245 offset:16896
    s_waitcnt lgkmcnt(5)
    v_mfma_f32_16x16x32_bf16 v[136:139], v[204:207], v[232:235], v[136:139]
    ds_read_b64_tr_b16 v[186:187], v245 offset:17920
    v_mfma_f32_16x16x32_bf16 v[140:143], v[200:203], v[236:239], v[140:143]
    ds_read_b64_tr_b16 v[188:189], v245 offset:25088
    v_mfma_f32_16x16x32_bf16 v[140:143], v[204:207], v[240:243], v[140:143]
    ds_read_b64_tr_b16 v[190:191], v245 offset:26112
    buffer_load_dwordx4 v83, s[40:43], s26 offen offset:3072 lds
    s_add_u32 s26, s26, 128
    s_waitcnt lgkmcnt(6)
    v_mfma_f32_16x16x32_bf16 v[144:147], v[176:179], v[228:231], v[144:147]
    ds_read_b64_tr_b16 v[192:193], v244 offset:17152
    s_waitcnt lgkmcnt(5)
    v_mfma_f32_16x16x32_bf16 v[144:147], v[180:183], v[232:235], v[144:147]
    ds_read_b64_tr_b16 v[194:195], v244 offset:18176
    v_mfma_f32_16x16x32_bf16 v[148:151], v[176:179], v[236:239], v[148:151]
    ds_read_b64_tr_b16 v[196:197], v244 offset:25344
    v_mfma_f32_16x16x32_bf16 v[148:151], v[180:183], v[240:243], v[148:151]
    ds_read_b64_tr_b16 v[198:199], v244 offset:26368
    s_add_u32 m0, s25, 0
    s_nop 0
    buffer_load_dwordx4 v246, s[36:39], s24 offen lds
    s_waitcnt lgkmcnt(6)
    v_mfma_f32_16x16x32_bf16 v[152:155], v[184:187], v[228:231], v[152:155]
    ds_read_b64_tr_b16 v[200:201], v245 offset:17152
    s_waitcnt lgkmcnt(5)
    v_mfma_f32_16x16x32_bf16 v[152:155], v[188:191], v[232:235], v[152:155]
    ds_read_b64_tr_b16 v[202:203], v245 offset:18176
    v_mfma_f32_16x16x32_bf16 v[156:159], v[184:187], v[236:239], v[156:159]
    ds_read_b64_tr_b16 v[204:205], v245 offset:25344
    v_mfma_f32_16x16x32_bf16 v[156:159], v[188:191], v[240:243], v[156:159]
    ds_read_b64_tr_b16 v[206:207], v245 offset:26368
    s_add_u32 m0, s25, 0
    s_nop 0
    buffer_load_dwordx4 v247, s[36:39], s24 offen offset:1024 lds
    s_add_u32 s24, s24, 524288
    s_waitcnt lgkmcnt(6)
    v_mfma_f32_16x16x32_bf16 v[160:163], v[192:195], v[228:231], v[160:163]
    ds_read_b64_tr_b16 v[176:177], v244 offset:32768
    s_waitcnt lgkmcnt(5)
    v_mfma_f32_16x16x32_bf16 v[160:163], v[196:199], v[232:235], v[160:163]
    ds_read_b64_tr_b16 v[178:179], v244 offset:33792
    v_mfma_f32_16x16x32_bf16 v[164:167], v[192:195], v[236:239], v[164:167]
    ds_read_b64_tr_b16 v[180:181], v244 offset:40960
    v_mfma_f32_16x16x32_bf16 v[164:167], v[196:199], v[240:243], v[164:167]
    ds_read_b64_tr_b16 v[182:183], v244 offset:41984
    s_waitcnt vmcnt(8)
    ds_read_b128 v[212:215], v248 offset:0
    ds_read_b128 v[216:219], v249 offset:0
    s_waitcnt lgkmcnt(8)
    v_mfma_f32_16x16x32_bf16 v[168:171], v[200:203], v[228:231], v[168:171]
    ds_read_b64_tr_b16 v[184:185], v245 offset:32768
    s_waitcnt lgkmcnt(7)
    v_mfma_f32_16x16x32_bf16 v[168:171], v[204:207], v[232:235], v[168:171]
    ds_read_b64_tr_b16 v[186:187], v245 offset:33792
    v_mfma_f32_16x16x32_bf16 v[172:175], v[200:203], v[236:239], v[172:175]
    ds_read_b64_tr_b16 v[188:189], v245 offset:40960
    v_mfma_f32_16x16x32_bf16 v[172:175], v[204:207], v[240:243], v[172:175]
    ds_read_b64_tr_b16 v[190:191], v245 offset:41984
    ds_read_b128 v[220:223], v248 offset:2048
    ds_read_b128 v[224:227], v249 offset:2048
    s_waitcnt vmcnt(6)
    s_barrier
    s_waitcnt lgkmcnt(7)
    v_mfma_f32_16x16x32_bf16 v[112:115], v[176:179], v[212:215], v[112:115]
    ds_read_b64_tr_b16 v[192:193], v244 offset:33024
    s_waitcnt lgkmcnt(7)
    v_mfma_f32_16x16x32_bf16 v[112:115], v[180:183], v[216:219], v[112:115]
    ds_read_b64_tr_b16 v[194:195], v244 offset:34048
    s_waitcnt lgkmcnt(3)
    v_mfma_f32_16x16x32_bf16 v[116:119], v[176:179], v[220:223], v[116:119]
    ds_read_b64_tr_b16 v[196:197], v244 offset:41216
    s_waitcnt lgkmcnt(3)
    v_mfma_f32_16x16x32_bf16 v[116:119], v[180:183], v[224:227], v[116:119]
    ds_read_b64_tr_b16 v[198:199], v244 offset:42240
    s_add_u32 m0, s100, 0
    s_nop 0
    buffer_load_dwordx4 v80, s[40:43], s26 offen offset:0 lds
    v_mfma_f32_16x16x32_bf16 v[120:123], v[184:187], v[212:215], v[120:123]
    ds_read_b64_tr_b16 v[200:201], v245 offset:33024
    v_mfma_f32_16x16x32_bf16 v[120:123], v[188:191], v[216:219], v[120:123]
    ds_read_b64_tr_b16 v[202:203], v245 offset:34048
    v_mfma_f32_16x16x32_bf16 v[124:127], v[184:187], v[220:223], v[124:127]
    ds_read_b64_tr_b16 v[204:205], v245 offset:41216
    v_mfma_f32_16x16x32_bf16 v[124:127], v[188:191], v[224:227], v[124:127]
    ds_read_b64_tr_b16 v[206:207], v245 offset:42240
    buffer_load_dwordx4 v81, s[40:43], s26 offen offset:1024 lds
    s_waitcnt lgkmcnt(6)
    v_mfma_f32_16x16x32_bf16 v[128:131], v[192:195], v[212:215], v[128:131]
    ds_read_b64_tr_b16 v[176:177], v244 offset:33280
    s_waitcnt lgkmcnt(5)
    v_mfma_f32_16x16x32_bf16 v[128:131], v[196:199], v[216:219], v[128:131]
    ds_read_b64_tr_b16 v[178:179], v244 offset:34304
    v_mfma_f32_16x16x32_bf16 v[132:135], v[192:195], v[220:223], v[132:135]
    ds_read_b64_tr_b16 v[180:181], v244 offset:41472
    v_mfma_f32_16x16x32_bf16 v[132:135], v[196:199], v[224:227], v[132:135]
    ds_read_b64_tr_b16 v[182:183], v244 offset:42496
    buffer_load_dwordx4 v82, s[40:43], s26 offen offset:2048 lds
    s_waitcnt lgkmcnt(6)
    v_mfma_f32_16x16x32_bf16 v[136:139], v[200:203], v[212:215], v[136:139]
    ds_read_b64_tr_b16 v[184:185], v245 offset:33280
    s_waitcnt lgkmcnt(5)
    v_mfma_f32_16x16x32_bf16 v[136:139], v[204:207], v[216:219], v[136:139]
    ds_read_b64_tr_b16 v[186:187], v245 offset:34304
    v_mfma_f32_16x16x32_bf16 v[140:143], v[200:203], v[220:223], v[140:143]
    ds_read_b64_tr_b16 v[188:189], v245 offset:41472
    v_mfma_f32_16x16x32_bf16 v[140:143], v[204:207], v[224:227], v[140:143]
    ds_read_b64_tr_b16 v[190:191], v245 offset:42496
    buffer_load_dwordx4 v83, s[40:43], s26 offen offset:3072 lds
    s_add_u32 s26, s26, 128
    s_waitcnt lgkmcnt(6)
    v_mfma_f32_16x16x32_bf16 v[144:147], v[176:179], v[212:215], v[144:147]
    ds_read_b64_tr_b16 v[192:193], v244 offset:33536
    s_waitcnt lgkmcnt(5)
    v_mfma_f32_16x16x32_bf16 v[144:147], v[180:183], v[216:219], v[144:147]
    ds_read_b64_tr_b16 v[194:195], v244 offset:34560
    v_mfma_f32_16x16x32_bf16 v[148:151], v[176:179], v[220:223], v[148:151]
    ds_read_b64_tr_b16 v[196:197], v244 offset:41728
    v_mfma_f32_16x16x32_bf16 v[148:151], v[180:183], v[224:227], v[148:151]
    ds_read_b64_tr_b16 v[198:199], v244 offset:42752
    s_add_u32 m0, s25, 16384
    s_nop 0
    buffer_load_dwordx4 v246, s[36:39], s24 offen lds
    s_waitcnt lgkmcnt(6)
    v_mfma_f32_16x16x32_bf16 v[152:155], v[184:187], v[212:215], v[152:155]
    ds_read_b64_tr_b16 v[200:201], v245 offset:33536
    s_waitcnt lgkmcnt(5)
    v_mfma_f32_16x16x32_bf16 v[152:155], v[188:191], v[216:219], v[152:155]
    ds_read_b64_tr_b16 v[202:203], v245 offset:34560
    v_mfma_f32_16x16x32_bf16 v[156:159], v[184:187], v[220:223], v[156:159]
    ds_read_b64_tr_b16 v[204:205], v245 offset:41728
    v_mfma_f32_16x16x32_bf16 v[156:159], v[188:191], v[224:227], v[156:159]
    ds_read_b64_tr_b16 v[206:207], v245 offset:42752
    s_add_u32 m0, s25, 16384
    s_nop 0
    buffer_load_dwordx4 v247, s[36:39], s24 offen offset:1024 lds
    s_add_u32 s24, s24, 524288
    s_waitcnt lgkmcnt(6)
    v_mfma_f32_16x16x32_bf16 v[160:163], v[192:195], v[212:215], v[160:163]
    ds_read_b64_tr_b16 v[176:177], v244 offset:49152
    s_waitcnt lgkmcnt(5)
    v_mfma_f32_16x16x32_bf16 v[160:163], v[196:199], v[216:219], v[160:163]
    ds_read_b64_tr_b16 v[178:179], v244 offset:50176
    v_mfma_f32_16x16x32_bf16 v[164:167], v[192:195], v[220:223], v[164:167]
    ds_read_b64_tr_b16 v[180:181], v244 offset:57344
    v_mfma_f32_16x16x32_bf16 v[164:167], v[196:199], v[224:227], v[164:167]
    ds_read_b64_tr_b16 v[182:183], v244 offset:58368
    s_waitcnt vmcnt(8)
    ds_read_b128 v[228:231], v248 offset:32768
    ds_read_b128 v[232:235], v249 offset:32768
    s_waitcnt lgkmcnt(8)
    v_mfma_f32_16x16x32_bf16 v[168:171], v[200:203], v[212:215], v[168:171]
    ds_read_b64_tr_b16 v[184:185], v245 offset:49152
    s_waitcnt lgkmcnt(7)
    v_mfma_f32_16x16x32_bf16 v[168:171], v[204:207], v[216:219], v[168:171]
    ds_read_b64_tr_b16 v[186:187], v245 offset:50176
    v_mfma_f32_16x16x32_bf16 v[172:175], v[200:203], v[220:223], v[172:175]
    ds_read_b64_tr_b16 v[188:189], v245 offset:57344
    v_mfma_f32_16x16x32_bf16 v[172:175], v[204:207], v[224:227], v[172:175]
    ds_read_b64_tr_b16 v[190:191], v245 offset:58368
    ds_read_b128 v[236:239], v248 offset:34816
    ds_read_b128 v[240:243], v249 offset:34816
    s_waitcnt vmcnt(6)
    s_barrier
    s_waitcnt lgkmcnt(7)
    v_mfma_f32_16x16x32_bf16 v[112:115], v[176:179], v[228:231], v[112:115]
    ds_read_b64_tr_b16 v[192:193], v244 offset:49408
    s_waitcnt lgkmcnt(7)
    v_mfma_f32_16x16x32_bf16 v[112:115], v[180:183], v[232:235], v[112:115]
    ds_read_b64_tr_b16 v[194:195], v244 offset:50432
    s_waitcnt lgkmcnt(3)
    v_mfma_f32_16x16x32_bf16 v[116:119], v[176:179], v[236:239], v[116:119]
    ds_read_b64_tr_b16 v[196:197], v244 offset:57600
    s_waitcnt lgkmcnt(3)
    v_mfma_f32_16x16x32_bf16 v[116:119], v[180:183], v[240:243], v[116:119]
    ds_read_b64_tr_b16 v[198:199], v244 offset:58624
    s_add_u32 m0, s100, 32768
    s_nop 0
    buffer_load_dwordx4 v80, s[40:43], s26 offen offset:0 lds
    v_mfma_f32_16x16x32_bf16 v[120:123], v[184:187], v[228:231], v[120:123]
    ds_read_b64_tr_b16 v[200:201], v245 offset:49408
    v_mfma_f32_16x16x32_bf16 v[120:123], v[188:191], v[232:235], v[120:123]
    ds_read_b64_tr_b16 v[202:203], v245 offset:50432
    v_mfma_f32_16x16x32_bf16 v[124:127], v[184:187], v[236:239], v[124:127]
    ds_read_b64_tr_b16 v[204:205], v245 offset:57600
    v_mfma_f32_16x16x32_bf16 v[124:127], v[188:191], v[240:243], v[124:127]
    ds_read_b64_tr_b16 v[206:207], v245 offset:58624
    buffer_load_dwordx4 v81, s[40:43], s26 offen offset:1024 lds
    s_waitcnt lgkmcnt(6)
    v_mfma_f32_16x16x32_bf16 v[128:131], v[192:195], v[228:231], v[128:131]
    ds_read_b64_tr_b16 v[176:177], v244 offset:49664
    s_waitcnt lgkmcnt(5)
    v_mfma_f32_16x16x32_bf16 v[128:131], v[196:199], v[232:235], v[128:131]
    ds_read_b64_tr_b16 v[178:179], v244 offset:50688
    v_mfma_f32_16x16x32_bf16 v[132:135], v[192:195], v[236:239], v[132:135]
    ds_read_b64_tr_b16 v[180:181], v244 offset:57856
    v_mfma_f32_16x16x32_bf16 v[132:135], v[196:199], v[240:243], v[132:135]
    ds_read_b64_tr_b16 v[182:183], v244 offset:58880
    buffer_load_dwordx4 v82, s[40:43], s26 offen offset:2048 lds
    s_waitcnt lgkmcnt(6)
    v_mfma_f32_16x16x32_bf16 v[136:139], v[200:203], v[228:231], v[136:139]
    ds_read_b64_tr_b16 v[184:185], v245 offset:49664
    s_waitcnt lgkmcnt(5)
    v_mfma_f32_16x16x32_bf16 v[136:139], v[204:207], v[232:235], v[136:139]
    ds_read_b64_tr_b16 v[186:187], v245 offset:50688
    v_mfma_f32_16x16x32_bf16 v[140:143], v[200:203], v[236:239], v[140:143]
    ds_read_b64_tr_b16 v[188:189], v245 offset:57856
    v_mfma_f32_16x16x32_bf16 v[140:143], v[204:207], v[240:243], v[140:143]
    ds_read_b64_tr_b16 v[190:191], v245 offset:58880
    buffer_load_dwordx4 v83, s[40:43], s26 offen offset:3072 lds
    s_add_u32 s26, s26, 128
    s_waitcnt lgkmcnt(6)
    v_mfma_f32_16x16x32_bf16 v[144:147], v[176:179], v[228:231], v[144:147]
    ds_read_b64_tr_b16 v[192:193], v244 offset:49920
    s_waitcnt lgkmcnt(5)
    v_mfma_f32_16x16x32_bf16 v[144:147], v[180:183], v[232:235], v[144:147]
    ds_read_b64_tr_b16 v[194:195], v244 offset:50944
    v_mfma_f32_16x16x32_bf16 v[148:151], v[176:179], v[236:239], v[148:151]
    ds_read_b64_tr_b16 v[196:197], v244 offset:58112
    v_mfma_f32_16x16x32_bf16 v[148:151], v[180:183], v[240:243], v[148:151]
    ds_read_b64_tr_b16 v[198:199], v244 offset:59136
    s_add_u32 m0, s25, 32768
    s_nop 0
    buffer_load_dwordx4 v246, s[36:39], s24 offen lds
    s_waitcnt lgkmcnt(6)
    v_mfma_f32_16x16x32_bf16 v[152:155], v[184:187], v[228:231], v[152:155]
    ds_read_b64_tr_b16 v[200:201], v245 offset:49920
    s_waitcnt lgkmcnt(5)
    v_mfma_f32_16x16x32_bf16 v[152:155], v[188:191], v[232:235], v[152:155]
    ds_read_b64_tr_b16 v[202:203], v245 offset:50944
    v_mfma_f32_16x16x32_bf16 v[156:159], v[184:187], v[236:239], v[156:159]
    ds_read_b64_tr_b16 v[204:205], v245 offset:58112
    v_mfma_f32_16x16x32_bf16 v[156:159], v[188:191], v[240:243], v[156:159]
    ds_read_b64_tr_b16 v[206:207], v245 offset:59136
    s_add_u32 m0, s25, 32768
    s_nop 0
    buffer_load_dwordx4 v247, s[36:39], s24 offen offset:1024 lds
    s_add_u32 s24, s24, 524288
    s_waitcnt lgkmcnt(6)
    v_mfma_f32_16x16x32_bf16 v[160:163], v[192:195], v[228:231], v[160:163]
    ds_read_b64_tr_b16 v[176:177], v244 offset:0
    s_waitcnt lgkmcnt(5)
    v_mfma_f32_16x16x32_bf16 v[160:163], v[196:199], v[232:235], v[160:163]
    ds_read_b64_tr_b16 v[178:179], v244 offset:1024
    v_mfma_f32_16x16x32_bf16 v[164:167], v[192:195], v[236:239], v[164:167]
    ds_read_b64_tr_b16 v[180:181], v244 offset:8192
    v_mfma_f32_16x16x32_bf16 v[164:167], v[196:199], v[240:243], v[164:167]
    ds_read_b64_tr_b16 v[182:183], v244 offset:9216
    s_waitcnt vmcnt(8)
    ds_read_b128 v[212:215], v248 offset:0
    ds_read_b128 v[216:219], v249 offset:0
    s_waitcnt lgkmcnt(8)
    v_mfma_f32_16x16x32_bf16 v[168:171], v[200:203], v[228:231], v[168:171]
    ds_read_b64_tr_b16 v[184:185], v245 offset:0
    s_waitcnt lgkmcnt(7)
    v_mfma_f32_16x16x32_bf16 v[168:171], v[204:207], v[232:235], v[168:171]
    ds_read_b64_tr_b16 v[186:187], v245 offset:1024
    v_mfma_f32_16x16x32_bf16 v[172:175], v[200:203], v[236:239], v[172:175]
    ds_read_b64_tr_b16 v[188:189], v245 offset:8192
    v_mfma_f32_16x16x32_bf16 v[172:175], v[204:207], v[240:243], v[172:175]
    ds_read_b64_tr_b16 v[190:191], v245 offset:9216
    ds_read_b128 v[220:223], v248 offset:2048
    ds_read_b128 v[224:227], v249 offset:2048
    s_waitcnt vmcnt(6)
    s_barrier
    s_waitcnt lgkmcnt(7)
    v_mfma_f32_16x16x32_bf16 v[112:115], v[176:179], v[212:215], v[112:115]
    ds_read_b64_tr_b16 v[192:193], v244 offset:256
    s_waitcnt lgkmcnt(7)
    v_mfma_f32_16x16x32_bf16 v[112:115], v[180:183], v[216:219], v[112:115]
    ds_read_b64_tr_b16 v[194:195], v244 offset:1280
    s_waitcnt lgkmcnt(3)
    v_mfma_f32_16x16x32_bf16 v[116:119], v[176:179], v[220:223], v[116:119]
    ds_read_b64_tr_b16 v[196:197], v244 offset:8448
    s_waitcnt lgkmcnt(3)
    v_mfma_f32_16x16x32_bf16 v[116:119], v[180:183], v[224:227], v[116:119]
    ds_read_b64_tr_b16 v[198:199], v244 offset:9472
    s_add_u32 m0, s100, 0
    s_nop 0
    buffer_load_dwordx4 v80, s[40:43], s26 offen offset:0 lds
    v_mfma_f32_16x16x32_bf16 v[120:123], v[184:187], v[212:215], v[120:123]
    ds_read_b64_tr_b16 v[200:201], v245 offset:256
    v_mfma_f32_16x16x32_bf16 v[120:123], v[188:191], v[216:219], v[120:123]
    ds_read_b64_tr_b16 v[202:203], v245 offset:1280
    v_mfma_f32_16x16x32_bf16 v[124:127], v[184:187], v[220:223], v[124:127]
    ds_read_b64_tr_b16 v[204:205], v245 offset:8448
    v_mfma_f32_16x16x32_bf16 v[124:127], v[188:191], v[224:227], v[124:127]
    ds_read_b64_tr_b16 v[206:207], v245 offset:9472
    buffer_load_dwordx4 v81, s[40:43], s26 offen offset:1024 lds
    s_waitcnt lgkmcnt(6)
    v_mfma_f32_16x16x32_bf16 v[128:131], v[192:195], v[212:215], v[128:131]
    ds_read_b64_tr_b16 v[176:177], v244 offset:512
    s_waitcnt lgkmcnt(5)
    v_mfma_f32_16x16x32_bf16 v[128:131], v[196:199], v[216:219], v[128:131]
    ds_read_b64_tr_b16 v[178:179], v244 offset:1536
    v_mfma_f32_16x16x32_bf16 v[132:135], v[192:195], v[220:223], v[132:135]
    ds_read_b64_tr_b16 v[180:181], v244 offset:8704
    v_mfma_f32_16x16x32_bf16 v[132:135], v[196:199], v[224:227], v[132:135]
    ds_read_b64_tr_b16 v[182:183], v244 offset:9728
    buffer_load_dwordx4 v82, s[40:43], s26 offen offset:2048 lds
    s_waitcnt lgkmcnt(6)
    v_mfma_f32_16x16x32_bf16 v[136:139], v[200:203], v[212:215], v[136:139]
    ds_read_b64_tr_b16 v[184:185], v245 offset:512
    s_waitcnt lgkmcnt(5)
    v_mfma_f32_16x16x32_bf16 v[136:139], v[204:207], v[216:219], v[136:139]
    ds_read_b64_tr_b16 v[186:187], v245 offset:1536
    v_mfma_f32_16x16x32_bf16 v[140:143], v[200:203], v[220:223], v[140:143]
    ds_read_b64_tr_b16 v[188:189], v245 offset:8704
    v_mfma_f32_16x16x32_bf16 v[140:143], v[204:207], v[224:227], v[140:143]
    ds_read_b64_tr_b16 v[190:191], v245 offset:9728
    buffer_load_dwordx4 v83, s[40:43], s26 offen offset:3072 lds
    s_add_u32 s26, s26, 128
    s_waitcnt lgkmcnt(6)
    v_mfma_f32_16x16x32_bf16 v[144:147], v[176:179], v[212:215], v[144:147]
    ds_read_b64_tr_b16 v[192:193], v244 offset:768
    s_waitcnt lgkmcnt(5)
    v_mfma_f32_16x16x32_bf16 v[144:147], v[180:183], v[216:219], v[144:147]
    ds_read_b64_tr_b16 v[194:195], v244 offset:1792
    v_mfma_f32_16x16x32_bf16 v[148:151], v[176:179], v[220:223], v[148:151]
    ds_read_b64_tr_b16 v[196:197], v244 offset:8960
    v_mfma_f32_16x16x32_bf16 v[148:151], v[180:183], v[224:227], v[148:151]
    ds_read_b64_tr_b16 v[198:199], v244 offset:9984
    s_add_u32 m0, s25, 49152
    s_nop 0
    buffer_load_dwordx4 v246, s[36:39], s24 offen lds
    s_waitcnt lgkmcnt(6)
    v_mfma_f32_16x16x32_bf16 v[152:155], v[184:187], v[212:215], v[152:155]
    ds_read_b64_tr_b16 v[200:201], v245 offset:768
    s_waitcnt lgkmcnt(5)
    v_mfma_f32_16x16x32_bf16 v[152:155], v[188:191], v[216:219], v[152:155]
    ds_read_b64_tr_b16 v[202:203], v245 offset:1792
    v_mfma_f32_16x16x32_bf16 v[156:159], v[184:187], v[220:223], v[156:159]
    ds_read_b64_tr_b16 v[204:205], v245 offset:8960
    v_mfma_f32_16x16x32_bf16 v[156:159], v[188:191], v[224:227], v[156:159]
    ds_read_b64_tr_b16 v[206:207], v245 offset:9984
    s_add_u32 m0, s25, 49152
    s_nop 0
    buffer_load_dwordx4 v247, s[36:39], s24 offen offset:1024 lds
    s_add_u32 s24, s24, 524288
    s_waitcnt lgkmcnt(6)
    v_mfma_f32_16x16x32_bf16 v[160:163], v[192:195], v[212:215], v[160:163]
    ds_read_b64_tr_b16 v[176:177], v244 offset:16384
    s_waitcnt lgkmcnt(5)
    v_mfma_f32_16x16x32_bf16 v[160:163], v[196:199], v[216:219], v[160:163]
    ds_read_b64_tr_b16 v[178:179], v244 offset:17408
    v_mfma_f32_16x16x32_bf16 v[164:167], v[192:195], v[220:223], v[164:167]
    ds_read_b64_tr_b16 v[180:181], v244 offset:24576
    v_mfma_f32_16x16x32_bf16 v[164:167], v[196:199], v[224:227], v[164:167]
    ds_read_b64_tr_b16 v[182:183], v244 offset:25600
    s_lshl_b32 s60, s21, 3
    s_add_u32 s60, s60, s3
    s_lshl_b32 s60, s60, 8
    s_add_u32 s60, s60, 5373952
    v_and_b32 v12, 15, v1
    v_lshlrev_b32 v12, 3, v12
    v_add_u32 v12, s60, v12
    global_load_dwordx2 v[250:251], v12, s[18:19] sc1
    global_load_dwordx2 v[252:253], v12, s[18:19] offset:128 sc1
    s_lshl_b32 s60, s20, 13
    s_lshl_b32 s61, s3, 7
    s_add_u32 s60, s60, s61
    s_add_u32 s60, s60, 5439488
    v_lshrrev_b32 v13, 3, v1
    v_lshlrev_b32 v13, 10, v13
    v_and_b32 v14, 7, v1
    v_lshl_add_u32 v13, v14, 4, v13
    v_add_u32 v13, s60, v13
    global_load_dwordx4 v[208:211], v13, s[18:19] sc1
    s_waitcnt vmcnt(11)
    ds_read_b128 v[228:231], v248 offset:32768
    ds_read_b128 v[232:235], v249 offset:32768
    s_waitcnt lgkmcnt(8)
    v_mfma_f32_16x16x32_bf16 v[168:171], v[200:203], v[212:215], v[168:171]
    ds_read_b64_tr_b16 v[184:185], v245 offset:16384
    s_waitcnt lgkmcnt(7)
    v_mfma_f32_16x16x32_bf16 v[168:171], v[204:207], v[216:219], v[168:171]
    ds_read_b64_tr_b16 v[186:187], v245 offset:17408
    v_mfma_f32_16x16x32_bf16 v[172:175], v[200:203], v[220:223], v[172:175]
    ds_read_b64_tr_b16 v[188:189], v245 offset:24576
    v_mfma_f32_16x16x32_bf16 v[172:175], v[204:207], v[224:227], v[172:175]
    ds_read_b64_tr_b16 v[190:191], v245 offset:25600
    s_add_u32 m0, s28, 131072
    s_nop 0
    buffer_load_dwordx4 v2, s[44:47], s27 offen lds
    s_add_u32 s27, s27, 8192
    ds_read_b128 v[236:239], v248 offset:34816
    ds_read_b128 v[240:243], v249 offset:34816
    s_waitcnt vmcnt(10)
    s_barrier
    s_waitcnt lgkmcnt(7)
    v_mfma_f32_16x16x32_bf16 v[112:115], v[176:179], v[228:231], v[112:115]
    ds_read_b64_tr_b16 v[192:193], v244 offset:16640
    s_waitcnt lgkmcnt(7)
    v_mfma_f32_16x16x32_bf16 v[112:115], v[180:183], v[232:235], v[112:115]
    ds_read_b64_tr_b16 v[194:195], v244 offset:17664
    s_waitcnt lgkmcnt(3)
    v_mfma_f32_16x16x32_bf16 v[116:119], v[176:179], v[236:239], v[116:119]
    ds_read_b64_tr_b16 v[196:197], v244 offset:24832
    s_waitcnt lgkmcnt(3)
    v_mfma_f32_16x16x32_bf16 v[116:119], v[180:183], v[240:243], v[116:119]
    ds_read_b64_tr_b16 v[198:199], v244 offset:25856
    s_add_u32 m0, s100, 32768
    s_nop 0
    buffer_load_dwordx4 v80, s[40:43], s26 offen offset:0 lds
    v_mfma_f32_16x16x32_bf16 v[120:123], v[184:187], v[228:231], v[120:123]
    ds_read_b64_tr_b16 v[200:201], v245 offset:16640
    v_mfma_f32_16x16x32_bf16 v[120:123], v[188:191], v[232:235], v[120:123]
    ds_read_b64_tr_b16 v[202:203], v245 offset:17664
    v_mfma_f32_16x16x32_bf16 v[124:127], v[184:187], v[236:239], v[124:127]
    ds_read_b64_tr_b16 v[204:205], v245 offset:24832
    v_mfma_f32_16x16x32_bf16 v[124:127], v[188:191], v[240:243], v[124:127]
    ds_read_b64_tr_b16 v[206:207], v245 offset:25856
    buffer_load_dwordx4 v81, s[40:43], s26 offen offset:1024 lds
    s_waitcnt lgkmcnt(6)
    v_mfma_f32_16x16x32_bf16 v[128:131], v[192:195], v[228:231], v[128:131]
    ds_read_b64_tr_b16 v[176:177], v244 offset:16896
    s_waitcnt lgkmcnt(5)
    v_mfma_f32_16x16x32_bf16 v[128:131], v[196:199], v[232:235], v[128:131]
    ds_read_b64_tr_b16 v[178:179], v244 offset:17920
    v_mfma_f32_16x16x32_bf16 v[132:135], v[192:195], v[236:239], v[132:135]
    ds_read_b64_tr_b16 v[180:181], v244 offset:25088
    v_mfma_f32_16x16x32_bf16 v[132:135], v[196:199], v[240:243], v[132:135]
    ds_read_b64_tr_b16 v[182:183], v244 offset:26112
    buffer_load_dwordx4 v82, s[40:43], s26 offen offset:2048 lds
    s_waitcnt lgkmcnt(6)
    v_mfma_f32_16x16x32_bf16 v[136:139], v[200:203], v[228:231], v[136:139]
    ds_read_b64_tr_b16 v[184:185], v245 offset:16896
    s_waitcnt lgkmcnt(5)
    v_mfma_f32_16x16x32_bf16 v[136:139], v[204:207], v[232:235], v[136:139]
    ds_read_b64_tr_b16 v[186:187], v245 offset:17920
    v_mfma_f32_16x16x32_bf16 v[140:143], v[200:203], v[236:239], v[140:143]
    ds_read_b64_tr_b16 v[188:189], v245 offset:25088
    v_mfma_f32_16x16x32_bf16 v[140:143], v[204:207], v[240:243], v[140:143]
    ds_read_b64_tr_b16 v[190:191], v245 offset:26112
    buffer_load_dwordx4 v83, s[40:43], s26 offen offset:3072 lds
    s_add_u32 s26, s26, 128
    s_waitcnt lgkmcnt(6)
    v_mfma_f32_16x16x32_bf16 v[144:147], v[176:179], v[228:231], v[144:147]
    ds_read_b64_tr_b16 v[192:193], v244 offset:17152
    s_waitcnt lgkmcnt(5)
    v_mfma_f32_16x16x32_bf16 v[144:147], v[180:183], v[232:235], v[144:147]
    ds_read_b64_tr_b16 v[194:195], v244 offset:18176
    v_mfma_f32_16x16x32_bf16 v[148:151], v[176:179], v[236:239], v[148:151]
    ds_read_b64_tr_b16 v[196:197], v244 offset:25344
    v_mfma_f32_16x16x32_bf16 v[148:151], v[180:183], v[240:243], v[148:151]
    ds_read_b64_tr_b16 v[198:199], v244 offset:26368
    s_add_u32 m0, s28, 139776
    s_nop 0
    buffer_load_dwordx4 v2, s[44:47], s27 offen lds
    s_add_u32 s27, s27, 8192
    s_waitcnt lgkmcnt(6)
    v_mfma_f32_16x16x32_bf16 v[152:155], v[184:187], v[228:231], v[152:155]
    ds_read_b64_tr_b16 v[200:201], v245 offset:17152
    s_waitcnt lgkmcnt(5)
    v_mfma_f32_16x16x32_bf16 v[152:155], v[188:191], v[232:235], v[152:155]
    ds_read_b64_tr_b16 v[202:203], v245 offset:18176
    v_mfma_f32_16x16x32_bf16 v[156:159], v[184:187], v[236:239], v[156:159]
    ds_read_b64_tr_b16 v[204:205], v245 offset:25344
    v_mfma_f32_16x16x32_bf16 v[156:159], v[188:191], v[240:243], v[156:159]
    ds_read_b64_tr_b16 v[206:207], v245 offset:26368
    s_add_u32 m0, s28, 148480
    s_nop 0
    buffer_load_dwordx4 v2, s[44:47], s27 offen lds
    s_add_u32 s27, s27, 8192
    s_waitcnt lgkmcnt(6)
    v_mfma_f32_16x16x32_bf16 v[160:163], v[192:195], v[228:231], v[160:163]
    ds_read_b64_tr_b16 v[176:177], v244 offset:32768
    s_waitcnt lgkmcnt(5)
    v_mfma_f32_16x16x32_bf16 v[160:163], v[196:199], v[232:235], v[160:163]
    ds_read_b64_tr_b16 v[178:179], v244 offset:33792
    v_mfma_f32_16x16x32_bf16 v[164:167], v[192:195], v[236:239], v[164:167]
    ds_read_b64_tr_b16 v[180:181], v244 offset:40960
    v_mfma_f32_16x16x32_bf16 v[164:167], v[196:199], v[240:243], v[164:167]
    ds_read_b64_tr_b16 v[182:183], v244 offset:41984
    s_waitcnt vmcnt(12)
    ds_read_b128 v[212:215], v248 offset:0
    ds_read_b128 v[216:219], v249 offset:0
    s_waitcnt lgkmcnt(8)
    v_mfma_f32_16x16x32_bf16 v[168:171], v[200:203], v[228:231], v[168:171]
    ds_read_b64_tr_b16 v[184:185], v245 offset:32768
    s_waitcnt lgkmcnt(7)
    v_mfma_f32_16x16x32_bf16 v[168:171], v[204:207], v[232:235], v[168:171]
    ds_read_b64_tr_b16 v[186:187], v245 offset:33792
    v_mfma_f32_16x16x32_bf16 v[172:175], v[200:203], v[236:239], v[172:175]
    ds_read_b64_tr_b16 v[188:189], v245 offset:40960
    v_mfma_f32_16x16x32_bf16 v[172:175], v[204:207], v[240:243], v[172:175]
    ds_read_b64_tr_b16 v[190:191], v245 offset:41984
    ds_read_b128 v[220:223], v248 offset:2048
    ds_read_b128 v[224:227], v249 offset:2048
    s_waitcnt vmcnt(10)
    s_waitcnt lgkmcnt(0)
    s_barrier
    v_mfma_f32_16x16x32_bf16 v[112:115], v[176:179], v[212:215], v[112:115]
    ds_read_b64_tr_b16 v[192:193], v244 offset:33024
    v_mfma_f32_16x16x32_bf16 v[112:115], v[180:183], v[216:219], v[112:115]
    ds_read_b64_tr_b16 v[194:195], v244 offset:34048
    v_mfma_f32_16x16x32_bf16 v[116:119], v[176:179], v[220:223], v[116:119]
    ds_read_b64_tr_b16 v[196:197], v244 offset:41216
    v_mfma_f32_16x16x32_bf16 v[116:119], v[180:183], v[224:227], v[116:119]
    ds_read_b64_tr_b16 v[198:199], v244 offset:42240
    s_add_u32 m0, s28, 65536
    s_nop 0
    buffer_load_dwordx4 v2, s[44:47], s27 offen lds
    s_add_u32 s27, s27, 8192
    v_mfma_f32_16x16x32_bf16 v[120:123], v[184:187], v[212:215], v[120:123]
    ds_read_b64_tr_b16 v[200:201], v245 offset:33024
    v_mfma_f32_16x16x32_bf16 v[120:123], v[188:191], v[216:219], v[120:123]
    ds_read_b64_tr_b16 v[202:203], v245 offset:34048
    v_mfma_f32_16x16x32_bf16 v[124:127], v[184:187], v[220:223], v[124:127]
    ds_read_b64_tr_b16 v[204:205], v245 offset:41216
    v_mfma_f32_16x16x32_bf16 v[124:127], v[188:191], v[224:227], v[124:127]
    ds_read_b64_tr_b16 v[206:207], v245 offset:42240
    s_add_u32 m0, s30, 74240
    s_nop 0
    buffer_load_dwordx4 v3, s[48:51], s29 offen lds
    s_add_u32 s29, s29, 8192
    s_waitcnt lgkmcnt(6)
    v_mfma_f32_16x16x32_bf16 v[128:131], v[192:195], v[212:215], v[128:131]
    ds_read_b64_tr_b16 v[176:177], v244 offset:33280
    s_waitcnt lgkmcnt(5)
    v_mfma_f32_16x16x32_bf16 v[128:131], v[196:199], v[216:219], v[128:131]
    ds_read_b64_tr_b16 v[178:179], v244 offset:34304
    v_mfma_f32_16x16x32_bf16 v[132:135], v[192:195], v[220:223], v[132:135]
    ds_read_b64_tr_b16 v[180:181], v244 offset:41472
    v_mfma_f32_16x16x32_bf16 v[132:135], v[196:199], v[224:227], v[132:135]
    ds_read_b64_tr_b16 v[182:183], v244 offset:42496
    s_add_u32 m0, s30, 82432
    s_nop 0
    buffer_load_dwordx4 v3, s[48:51], s29 offen lds
    s_add_u32 s29, s29, 8192
    s_waitcnt lgkmcnt(6)
    v_mfma_f32_16x16x32_bf16 v[136:139], v[200:203], v[212:215], v[136:139]
    ds_read_b64_tr_b16 v[184:185], v245 offset:33280
    s_waitcnt lgkmcnt(5)
    v_mfma_f32_16x16x32_bf16 v[136:139], v[204:207], v[216:219], v[136:139]
    ds_read_b64_tr_b16 v[186:187], v245 offset:34304
    v_mfma_f32_16x16x32_bf16 v[140:143], v[200:203], v[220:223], v[140:143]
    ds_read_b64_tr_b16 v[188:189], v245 offset:41472
    v_mfma_f32_16x16x32_bf16 v[140:143], v[204:207], v[224:227], v[140:143]
    ds_read_b64_tr_b16 v[190:191], v245 offset:42496
    s_waitcnt lgkmcnt(6)
    v_mfma_f32_16x16x32_bf16 v[144:147], v[176:179], v[212:215], v[144:147]
    ds_read_b64_tr_b16 v[192:193], v244 offset:33536
    s_waitcnt lgkmcnt(5)
    v_mfma_f32_16x16x32_bf16 v[144:147], v[180:183], v[216:219], v[144:147]
    ds_read_b64_tr_b16 v[194:195], v244 offset:34560
    v_mfma_f32_16x16x32_bf16 v[148:151], v[176:179], v[220:223], v[148:151]
    ds_read_b64_tr_b16 v[196:197], v244 offset:41728
    v_mfma_f32_16x16x32_bf16 v[148:151], v[180:183], v[224:227], v[148:151]
    ds_read_b64_tr_b16 v[198:199], v244 offset:42752
    s_waitcnt vmcnt(10)
    v_xor_b32 v12, s33, v251
    v_xor_b32 v13, s33, v253
    v_xor_b32 v14, s33, v209
    v_xor_b32 v15, s33, v211
    v_or3_b32 v12, v12, v13, v14
    v_or_b32 v12, v12, v15
    v_cmp_ne_u32 vcc, 0, v12
    s_mov_b32 s73, 20000
    s_cbranch_vccnz M_SSPIN
M_SSPIN_RET:
    v_add_f32_dpp v208, v208, v208 row_ror:8 row_mask:0xf bank_mask:0xf
    v_add_f32_dpp v210, v210, v210 row_ror:8 row_mask:0xf bank_mask:0xf
    v_mov_b32 v209, v208
    v_mov_b32 v211, v210
    s_nop 0
    v_permlane16_swap_b32 v208, v209
    v_permlane16_swap_b32 v210, v211
    v_add_f32 v208, v208, v209
    v_add_f32 v210, v210, v211
    v_mov_b32 v209, v208
    v_mov_b32 v211, v210
    s_nop 0
    v_permlane32_swap_b32 v208, v209
    v_permlane32_swap_b32 v210, v211
    v_add_f32 v208, v208, v209
    v_add_f32 v210, v210, v211
    v_mov_b32 v209, v210
    v_and_b32 v12, 7, v1
    v_lshlrev_b32 v12, 3, v12
    s_lshl_b32 s60, s3, 6
    s_add_u32 s60, s60, 159744
    v_add_u32 v12, s60, v12
    ds_write_b64 v12, v[208:209]
    v_and_b32 v251, 0xffff0000, v250
    v_and_b32 v253, 0xffff0000, v252
    v_rcp_f32 v251, v251
    v_rcp_f32 v253, v253
    v_lshlrev_b32 v250, 16, v250
    v_lshlrev_b32 v252, 16, v252
    v_mul_f32 v251, 0x3e0293ee, v251
    v_mul_f32 v253, 0x3e0293ee, v253
    s_waitcnt lgkmcnt(7)
    v_mfma_f32_16x16x32_bf16 v[152:155], v[184:187], v[212:215], v[152:155]
    ds_read_b64_tr_b16 v[200:201], v245 offset:33536
    s_waitcnt lgkmcnt(6)
    v_mfma_f32_16x16x32_bf16 v[152:155], v[188:191], v[216:219], v[152:155]
    ds_read_b64_tr_b16 v[202:203], v245 offset:34560
    v_mfma_f32_16x16x32_bf16 v[156:159], v[184:187], v[220:223], v[156:159]
    ds_read_b64_tr_b16 v[204:205], v245 offset:41728
    v_mfma_f32_16x16x32_bf16 v[156:159], v[188:191], v[224:227], v[156:159]
    ds_read_b64_tr_b16 v[206:207], v245 offset:42752
    s_waitcnt lgkmcnt(7)
    v_mfma_f32_16x16x32_bf16 v[160:163], v[192:195], v[212:215], v[160:163]
    ds_read_b64_tr_b16 v[176:177], v244 offset:49152
    s_waitcnt lgkmcnt(6)
    v_mfma_f32_16x16x32_bf16 v[160:163], v[196:199], v[216:219], v[160:163]
    ds_read_b64_tr_b16 v[178:179], v244 offset:50176
    v_mfma_f32_16x16x32_bf16 v[164:167], v[192:195], v[220:223], v[164:167]
    ds_read_b64_tr_b16 v[180:181], v244 offset:57344
    v_mfma_f32_16x16x32_bf16 v[164:167], v[196:199], v[224:227], v[164:167]
    ds_read_b64_tr_b16 v[182:183], v244 offset:58368
    s_waitcnt vmcnt(5)
    ds_read_b128 v[228:231], v248 offset:32768
    ds_read_b128 v[232:235], v249 offset:32768
    s_waitcnt lgkmcnt(8)
    v_mfma_f32_16x16x32_bf16 v[168:171], v[200:203], v[212:215], v[168:171]
    ds_read_b64_tr_b16 v[184:185], v245 offset:49152
    s_waitcnt lgkmcnt(7)
    v_mfma_f32_16x16x32_bf16 v[168:171], v[204:207], v[216:219], v[168:171]
    ds_read_b64_tr_b16 v[186:187], v245 offset:50176
    v_mfma_f32_16x16x32_bf16 v[172:175], v[200:203], v[220:223], v[172:175]
    ds_read_b64_tr_b16 v[188:189], v245 offset:57344
    v_mfma_f32_16x16x32_bf16 v[172:175], v[204:207], v[224:227], v[172:175]
    ds_read_b64_tr_b16 v[190:191], v245 offset:58368
    ds_read_b128 v[236:239], v248 offset:34816
    ds_read_b128 v[240:243], v249 offset:34816
    s_waitcnt vmcnt(4)
    s_waitcnt lgkmcnt(0)
    s_barrier
    v_mfma_f32_16x16x32_bf16 v[112:115], v[176:179], v[228:231], v[112:115]
    ds_read_b64_tr_b16 v[192:193], v244 offset:49408
    v_mfma_f32_16x16x32_bf16 v[112:115], v[180:183], v[232:235], v[112:115]
    ds_read_b64_tr_b16 v[194:195], v244 offset:50432
    v_mfma_f32_16x16x32_bf16 v[116:119], v[176:179], v[236:239], v[116:119]
    ds_read_b64_tr_b16 v[196:197], v244 offset:57600
    v_mfma_f32_16x16x32_bf16 v[116:119], v[180:183], v[240:243], v[116:119]
    ds_read_b64_tr_b16 v[198:199], v244 offset:58624
    s_add_u32 m0, s28, 90624
    s_nop 0
    buffer_load_dwordx4 v2, s[44:47], s27 offen lds
    s_add_u32 s27, s27, 8192
    v_mfma_f32_16x16x32_bf16 v[120:123], v[184:187], v[228:231], v[120:123]
    ds_read_b64_tr_b16 v[200:201], v245 offset:49408
    v_mfma_f32_16x16x32_bf16 v[120:123], v[188:191], v[232:235], v[120:123]
    ds_read_b64_tr_b16 v[202:203], v245 offset:50432
    v_mfma_f32_16x16x32_bf16 v[124:127], v[184:187], v[236:239], v[124:127]
    ds_read_b64_tr_b16 v[204:205], v245 offset:57600
    v_mfma_f32_16x16x32_bf16 v[124:127], v[188:191], v[240:243], v[124:127]
    ds_read_b64_tr_b16 v[206:207], v245 offset:58624
    s_add_u32 m0, s28, 99328
    s_nop 0
    buffer_load_dwordx4 v2, s[44:47], s27 offen lds
    s_add_u32 s27, s27, 8192
    s_waitcnt lgkmcnt(6)
    v_mfma_f32_16x16x32_bf16 v[128:131], v[192:195], v[228:231], v[128:131]
    ds_read_b64_tr_b16 v[176:177], v244 offset:49664
    s_waitcnt lgkmcnt(5)
    v_mfma_f32_16x16x32_bf16 v[128:131], v[196:199], v[232:235], v[128:131]
    ds_read_b64_tr_b16 v[178:179], v244 offset:50688
    v_mfma_f32_16x16x32_bf16 v[132:135], v[192:195], v[236:239], v[132:135]
    ds_read_b64_tr_b16 v[180:181], v244 offset:57856
    v_mfma_f32_16x16x32_bf16 v[132:135], v[196:199], v[240:243], v[132:135]
    ds_read_b64_tr_b16 v[182:183], v244 offset:58880
    s_add_u32 m0, s30, 116736
    s_nop 0
    buffer_load_dwordx4 v3, s[48:51], s29 offen lds
    s_add_u32 s29, s29, 8192
    s_waitcnt lgkmcnt(6)
    v_mfma_f32_16x16x32_bf16 v[136:139], v[200:203], v[228:231], v[136:139]
    ds_read_b64_tr_b16 v[184:185], v245 offset:49664
    s_waitcnt lgkmcnt(5)
    v_mfma_f32_16x16x32_bf16 v[136:139], v[204:207], v[232:235], v[136:139]
    ds_read_b64_tr_b16 v[186:187], v245 offset:50688
    v_mfma_f32_16x16x32_bf16 v[140:143], v[200:203], v[236:239], v[140:143]
    ds_read_b64_tr_b16 v[188:189], v245 offset:57856
    v_mfma_f32_16x16x32_bf16 v[140:143], v[204:207], v[240:243], v[140:143]
    ds_read_b64_tr_b16 v[190:191], v245 offset:58880
    s_add_u32 m0, s28, 108032
    s_nop 0
    buffer_load_dwordx4 v2, s[44:47], s27 offen lds
    s_add_u32 s27, s27, 8192
    s_waitcnt lgkmcnt(6)
    v_mfma_f32_16x16x32_bf16 v[144:147], v[176:179], v[228:231], v[144:147]
    ds_read_b64_tr_b16 v[192:193], v244 offset:49920
    s_waitcnt lgkmcnt(5)
    v_mfma_f32_16x16x32_bf16 v[144:147], v[180:183], v[232:235], v[144:147]
    ds_read_b64_tr_b16 v[194:195], v244 offset:50944
    v_mfma_f32_16x16x32_bf16 v[148:151], v[176:179], v[236:239], v[148:151]
    ds_read_b64_tr_b16 v[196:197], v244 offset:58112
    v_mfma_f32_16x16x32_bf16 v[148:151], v[180:183], v[240:243], v[148:151]
    ds_read_b64_tr_b16 v[198:199], v244 offset:59136
    s_waitcnt lgkmcnt(6)
    v_mfma_f32_16x16x32_bf16 v[152:155], v[184:187], v[228:231], v[152:155]
    ds_read_b64_tr_b16 v[200:201], v245 offset:49920
    s_waitcnt lgkmcnt(5)
    v_mfma_f32_16x16x32_bf16 v[152:155], v[188:191], v[232:235], v[152:155]
    ds_read_b64_tr_b16 v[202:203], v245 offset:50944
    v_mfma_f32_16x16x32_bf16 v[156:159], v[184:187], v[236:239], v[156:159]
    ds_read_b64_tr_b16 v[204:205], v245 offset:58112
    v_mfma_f32_16x16x32_bf16 v[156:159], v[188:191], v[240:243], v[156:159]
    ds_read_b64_tr_b16 v[206:207], v245 offset:59136
    s_waitcnt lgkmcnt(6)
    v_mfma_f32_16x16x32_bf16 v[160:163], v[192:195], v[228:231], v[160:163]
    s_waitcnt lgkmcnt(4)
    v_mfma_f32_16x16x32_bf16 v[160:163], v[196:199], v[232:235], v[160:163]
    v_mfma_f32_16x16x32_bf16 v[164:167], v[192:195], v[236:239], v[164:167]
    v_mfma_f32_16x16x32_bf16 v[164:167], v[196:199], v[240:243], v[164:167]
    s_waitcnt lgkmcnt(2)
    v_mfma_f32_16x16x32_bf16 v[168:171], v[200:203], v[228:231], v[168:171]
    s_waitcnt lgkmcnt(0)
    v_mfma_f32_16x16x32_bf16 v[168:171], v[204:207], v[232:235], v[168:171]
    v_mfma_f32_16x16x32_bf16 v[172:175], v[200:203], v[236:239], v[172:175]
    v_mfma_f32_16x16x32_bf16 v[172:175], v[204:207], v[240:243], v[172:175]
    v_lshrrev_b32 v12, 4, v1
    v_lshlrev_b32 v12, 4, v12
    v_add_u32 v12, 159744, v12
    ds_read_b128 v[212:215], v12 offset:0
    ds_read_b128 v[216:219], v12 offset:64
    ds_read_b128 v[220:223], v12 offset:128
    ds_read_b128 v[224:227], v12 offset:192
    ds_read_b128 v[228:231], v12 offset:256
    ds_read_b128 v[232:235], v12 offset:320
    ds_read_b128 v[236:239], v12 offset:384
    ds_read_b128 v[240:243], v12 offset:448
    ds_read_b128 v[176:179], v11 offset:0
    ds_read_b128 v[180:183], v11 offset:128
    ds_read_b128 v[184:187], v11 offset:256
    ds_read_b128 v[188:191], v11 offset:384
    s_waitcnt lgkmcnt(11)
    v_fma_f32 v112, -v250, v212, v112
    v_fma_f32 v113, -v250, v213, v113
    v_fma_f32 v114, -v250, v214, v114
    v_fma_f32 v115, -v250, v215, v115
    v_mul_f32 v112, v251, v112
    v_mul_f32 v113, v251, v113
    v_mul_f32 v114, v251, v114
    v_mul_f32 v115, v251, v115
    v_fma_f32 v116, -v252, v212, v116
    v_fma_f32 v117, -v252, v213, v117
    v_fma_f32 v118, -v252, v214, v118
    v_fma_f32 v119, -v252, v215, v119
    v_mul_f32 v116, v253, v116
    v_mul_f32 v117, v253, v117
    v_mul_f32 v118, v253, v118
    v_mul_f32 v119, v253, v119
    v_cvt_pk_bf16_f32 v80, v112, v113
    v_cvt_pk_bf16_f32 v81, v114, v115
    v_cvt_pk_bf16_f32 v82, v116, v117
    v_cvt_pk_bf16_f32 v83, v118, v119
    s_waitcnt lgkmcnt(10)
    v_fma_f32 v120, -v250, v216, v120
    v_fma_f32 v121, -v250, v217, v121
    v_fma_f32 v122, -v250, v218, v122
    v_fma_f32 v123, -v250, v219, v123
    v_mul_f32 v120, v251, v120
    v_mul_f32 v121, v251, v121
    v_mul_f32 v122, v251, v122
    v_mul_f32 v123, v251, v123
    v_fma_f32 v124, -v252, v216, v124
    v_fma_f32 v125, -v252, v217, v125
    v_fma_f32 v126, -v252, v218, v126
    v_fma_f32 v127, -v252, v219, v127
    v_mul_f32 v124, v253, v124
    v_mul_f32 v125, v253, v125
    v_mul_f32 v126, v253, v126
    v_mul_f32 v127, v253, v127
    v_cvt_pk_bf16_f32 v84, v120, v121
    v_cvt_pk_bf16_f32 v85, v122, v123
    v_cvt_pk_bf16_f32 v86, v124, v125
    v_cvt_pk_bf16_f32 v87, v126, v127
    v_permlane16_swap_b32 v80, v82
    v_permlane16_swap_b32 v81, v83
    s_waitcnt lgkmcnt(9)
    v_fma_f32 v128, -v250, v220, v128
    v_fma_f32 v129, -v250, v221, v129
    v_fma_f32 v130, -v250, v222, v130
    v_fma_f32 v131, -v250, v223, v131
    v_mul_f32 v128, v251, v128
    v_mul_f32 v129, v251, v129
    v_mul_f32 v130, v251, v130
    v_mul_f32 v131, v251, v131
    v_fma_f32 v132, -v252, v220, v132
    v_fma_f32 v133, -v252, v221, v133
    v_fma_f32 v134, -v252, v222, v134
    v_fma_f32 v135, -v252, v223, v135
    v_mul_f32 v132, v253, v132
    v_mul_f32 v133, v253, v133
    v_mul_f32 v134, v253, v134
    v_mul_f32 v135, v253, v135
    v_cvt_pk_bf16_f32 v88, v128, v129
    v_cvt_pk_bf16_f32 v89, v130, v131
    v_cvt_pk_bf16_f32 v90, v132, v133
    v_cvt_pk_bf16_f32 v91, v134, v135
    v_permlane16_swap_b32 v84, v86
    v_permlane16_swap_b32 v85, v87
    s_waitcnt lgkmcnt(8)
    v_fma_f32 v136, -v250, v224, v136
    v_fma_f32 v137, -v250, v225, v137
    v_fma_f32 v138, -v250, v226, v138
    v_fma_f32 v139, -v250, v227, v139
    v_mul_f32 v136, v251, v136
    v_mul_f32 v137, v251, v137
    v_mul_f32 v138, v251, v138
    v_mul_f32 v139, v251, v139
    v_fma_f32 v140, -v252, v224, v140
    v_fma_f32 v141, -v252, v225, v141
    v_fma_f32 v142, -v252, v226, v142
    v_fma_f32 v143, -v252, v227, v143
    v_mul_f32 v140, v253, v140
    v_mul_f32 v141, v253, v141
    v_mul_f32 v142, v253, v142
    v_mul_f32 v143, v253, v143
    v_cvt_pk_bf16_f32 v92, v136, v137
    v_cvt_pk_bf16_f32 v93, v138, v139
    v_cvt_pk_bf16_f32 v94, v140, v141
    v_cvt_pk_bf16_f32 v95, v142, v143
    v_permlane16_swap_b32 v88, v90
    v_permlane16_swap_b32 v89, v91
    s_waitcnt lgkmcnt(7)
    v_fma_f32 v144, -v250, v228, v144
    v_fma_f32 v145, -v250, v229, v145
    v_fma_f32 v146, -v250, v230, v146
    v_fma_f32 v147, -v250, v231, v147
    v_mul_f32 v144, v251, v144
    v_mul_f32 v145, v251, v145
    v_mul_f32 v146, v251, v146
    v_mul_f32 v147, v251, v147
    v_fma_f32 v148, -v252, v228, v148
    v_fma_f32 v149, -v252, v229, v149
    v_fma_f32 v150, -v252, v230, v150
    v_fma_f32 v151, -v252, v231, v151
    v_mul_f32 v148, v253, v148
    v_mul_f32 v149, v253, v149
    v_mul_f32 v150, v253, v150
    v_mul_f32 v151, v253, v151
    v_cvt_pk_bf16_f32 v96, v144, v145
    v_cvt_pk_bf16_f32 v97, v146, v147
    v_cvt_pk_bf16_f32 v98, v148, v149
    v_cvt_pk_bf16_f32 v99, v150, v151
    v_permlane16_swap_b32 v92, v94
    v_permlane16_swap_b32 v93, v95
    s_waitcnt lgkmcnt(6)
    v_fma_f32 v152, -v250, v232, v152
    v_fma_f32 v153, -v250, v233, v153
    v_fma_f32 v154, -v250, v234, v154
    v_fma_f32 v155, -v250, v235, v155
    v_mul_f32 v152, v251, v152
    v_mul_f32 v153, v251, v153
    v_mul_f32 v154, v251, v154
    v_mul_f32 v155, v251, v155
    v_fma_f32 v156, -v252, v232, v156
    v_fma_f32 v157, -v252, v233, v157
    v_fma_f32 v158, -v252, v234, v158
    v_fma_f32 v159, -v252, v235, v159
    v_mul_f32 v156, v253, v156
    v_mul_f32 v157, v253, v157
    v_mul_f32 v158, v253, v158
    v_mul_f32 v159, v253, v159
    v_cvt_pk_bf16_f32 v100, v152, v153
    v_cvt_pk_bf16_f32 v101, v154, v155
    v_cvt_pk_bf16_f32 v102, v156, v157
    v_cvt_pk_bf16_f32 v103, v158, v159
    v_permlane16_swap_b32 v96, v98
    v_permlane16_swap_b32 v97, v99
    s_waitcnt lgkmcnt(5)
    v_fma_f32 v160, -v250, v236, v160
    v_fma_f32 v161, -v250, v237, v161
    v_fma_f32 v162, -v250, v238, v162
    v_fma_f32 v163, -v250, v239, v163
    v_mul_f32 v160, v251, v160
    v_mul_f32 v161, v251, v161
    v_mul_f32 v162, v251, v162
    v_mul_f32 v163, v251, v163
    v_fma_f32 v164, -v252, v236, v164
    v_fma_f32 v165, -v252, v237, v165
    v_fma_f32 v166, -v252, v238, v166
    v_fma_f32 v167, -v252, v239, v167
    v_mul_f32 v164, v253, v164
    v_mul_f32 v165, v253, v165
    v_mul_f32 v166, v253, v166
    v_mul_f32 v167, v253, v167
    v_cvt_pk_bf16_f32 v104, v160, v161
    v_cvt_pk_bf16_f32 v105, v162, v163
    v_cvt_pk_bf16_f32 v106, v164, v165
    v_cvt_pk_bf16_f32 v107, v166, v167
    v_permlane16_swap_b32 v100, v102
    v_permlane16_swap_b32 v101, v103
    s_waitcnt lgkmcnt(4)
    v_fma_f32 v168, -v250, v240, v168
    v_fma_f32 v169, -v250, v241, v169
    v_fma_f32 v170, -v250, v242, v170
    v_fma_f32 v171, -v250, v243, v171
    v_mul_f32 v168, v251, v168
    v_mul_f32 v169, v251, v169
    v_mul_f32 v170, v251, v170
    v_mul_f32 v171, v251, v171
    v_fma_f32 v172, -v252, v240, v172
    v_fma_f32 v173, -v252, v241, v173
    v_fma_f32 v174, -v252, v242, v174
    v_fma_f32 v175, -v252, v243, v175
    v_mul_f32 v172, v253, v172
    v_mul_f32 v173, v253, v173
    v_mul_f32 v174, v253, v174
    v_mul_f32 v175, v253, v175
    v_cvt_pk_bf16_f32 v108, v168, v169
    v_cvt_pk_bf16_f32 v109, v170, v171
    v_cvt_pk_bf16_f32 v110, v172, v173
    v_cvt_pk_bf16_f32 v111, v174, v175
    v_permlane16_swap_b32 v104, v106
    v_permlane16_swap_b32 v105, v107
    v_permlane16_swap_b32 v108, v110
    v_permlane16_swap_b32 v109, v111
    s_waitcnt lgkmcnt(3)
    v_mfma_f32_32x32x16_bf16 v[112:127], v[176:179], v[80:83], 0
    ds_read_b128 v[176:179], v11 offset:512
    s_waitcnt lgkmcnt(3)
    v_mfma_f32_32x32x16_bf16 v[112:127], v[180:183], v[84:87], v[112:127]
    ds_read_b128 v[180:183], v11 offset:640
    s_waitcnt lgkmcnt(3)
    v_mfma_f32_32x32x16_bf16 v[112:127], v[184:187], v[88:91], v[112:127]
    ds_read_b128 v[184:187], v11 offset:768
    s_waitcnt lgkmcnt(3)
    v_mfma_f32_32x32x16_bf16 v[112:127], v[188:191], v[92:95], v[112:127]
    ds_read_b128 v[188:191], v11 offset:896
    s_waitcnt lgkmcnt(3)
    v_mfma_f32_32x32x16_bf16 v[112:127], v[176:179], v[96:99], v[112:127]
    ds_read_b128 v[176:179], v11 offset:8704
    s_waitcnt lgkmcnt(3)
    v_mfma_f32_32x32x16_bf16 v[112:127], v[180:183], v[100:103], v[112:127]
    ds_read_b128 v[180:183], v11 offset:8832
    s_waitcnt lgkmcnt(3)
    v_mfma_f32_32x32x16_bf16 v[112:127], v[184:187], v[104:107], v[112:127]
    ds_read_b128 v[184:187], v11 offset:8960
    s_waitcnt lgkmcnt(3)
    v_mfma_f32_32x32x16_bf16 v[112:127], v[188:191], v[108:111], v[112:127]
    ds_read_b128 v[188:191], v11 offset:9088
    s_waitcnt vmcnt(4)
    s_barrier
    s_cmp_lg_u32 s3, 4
    s_nop 6
    s_cbranch_scc1 M_NOKEY
    s_lshl_b32 s60, s65, 3
    s_add_u32 s60, s60, 4194304
    v_mov_b32 v12, s60
    v_mov_b32 v248, s34
    v_mov_b32 v249, s33
    s_mov_b64 exec, 1
    global_store_dwordx2 v12, v[248:249], s[18:19] sc1
    s_mov_b64 exec, -1
M_NOKEY:
    v_max3_f32 v12, v112, v113, v114
    v_max3_f32 v13, v115, v116, v117
    v_max3_f32 v12, v12, v118, v119
    v_max3_f32 v13, v13, v120, v121
    v_max3_f32 v12, v12, v122, v123
    v_max3_f32 v13, v13, v124, v125
    v_max3_f32 v12, v12, v126, v127
    v_max_f32 v12, v12, v13
    v_mov_b32 v13, v12
    s_nop 1
    v_permlane32_swap_b32 v12, v13
    v_max_f32 v12, v12, v13
    v_sub_f32 v144, 0, v12
    v_sub_f32 v145, 0, v12
    v_sub_f32 v146, 0, v12
    v_sub_f32 v147, 0, v12
    v_sub_f32 v148, 0, v12
    v_sub_f32 v149, 0, v12
    v_sub_f32 v150, 0, v12
    v_sub_f32 v151, 0, v12
    v_sub_f32 v152, 0, v12
    v_sub_f32 v153, 0, v12
    v_sub_f32 v154, 0, v12
    v_sub_f32 v155, 0, v12
    v_sub_f32 v156, 0, v12
    v_sub_f32 v157, 0, v12
    v_sub_f32 v158, 0, v12
    v_sub_f32 v159, 0, v12
    v_sub_f32 v112, v112, v12
    v_sub_f32 v113, v113, v12
    v_sub_f32 v114, v114, v12
    v_sub_f32 v115, v115, v12
    v_sub_f32 v116, v116, v12
    v_sub_f32 v117, v117, v12
    v_sub_f32 v118, v118, v12
    v_sub_f32 v119, v119, v12
    v_sub_f32 v120, v120, v12
    v_sub_f32 v121, v121, v12
    v_sub_f32 v122, v122, v12
    v_sub_f32 v123, v123, v12
    v_sub_f32 v124, v124, v12
    v_sub_f32 v125, v125, v12
    v_sub_f32 v126, v126, v12
    v_sub_f32 v127, v127, v12
    v_mov_b32 v14, 156032
    v_mov_b32 v15, 0
    ds_write_b32 v14, v15
    ds_write_b32 v14, v15 offset:1088
    s_mov_b32 s0, 0x3f803f80
    s_waitcnt lgkmcnt(5)
    v_mfma_f32_32x32x16_bf16 v[128:143], v[176:179], v[80:83], v[144:159]
    v_exp_f32 v208, v112
    v_exp_f32 v209, v113
    ds_read_b128 v[176:179], v11 offset:9216
    s_add_u32 m0, s28, 131072
    s_nop 0
    buffer_load_dwordx4 v2, s[44:47], s27 offen lds
    s_add_u32 s27, s27, 8192
    s_waitcnt lgkmcnt(5)
    v_mfma_f32_32x32x16_bf16 v[128:143], v[180:183], v[84:87], v[128:143]
    v_add_f32 v8, v8, v208
    v_add_f32 v9, v9, v209
    v_cvt_pk_bf16_f32 v160, v208, v209
    v_exp_f32 v210, v114
    v_exp_f32 v211, v115
    ds_read_b128 v[180:183], v11 offset:9344
    s_waitcnt lgkmcnt(5)
    v_mfma_f32_32x32x16_bf16 v[128:143], v[184:187], v[88:91], v[128:143]
    v_add_f32 v8, v8, v210
    v_add_f32 v9, v9, v211
    v_cvt_pk_bf16_f32 v161, v210, v211
    v_exp_f32 v208, v116
    v_exp_f32 v209, v117
    ds_read_b128 v[184:187], v11 offset:9472
    s_add_u32 m0, s30, 0
    s_nop 0
    buffer_load_dwordx4 v3, s[48:51], s29 offen lds
    s_add_u32 s29, s29, 8192
    s_waitcnt lgkmcnt(5)
    v_mfma_f32_32x32x16_bf16 v[128:143], v[188:191], v[92:95], v[128:143]
    v_add_f32 v8, v8, v208
    v_add_f32 v9, v9, v209
    v_cvt_pk_bf16_f32 v162, v208, v209
    v_exp_f32 v210, v118
    v_exp_f32 v211, v119
    ds_read_b128 v[188:191], v11 offset:9600
    s_waitcnt lgkmcnt(3)
    v_mfma_f32_32x32x16_bf16 v[128:143], v[176:179], v[96:99], v[128:143]
    v_add_f32 v8, v8, v210
    v_add_f32 v9, v9, v211
    v_cvt_pk_bf16_f32 v163, v210, v211
    v_exp_f32 v208, v120
    v_exp_f32 v209, v121
    ds_read_b128 v[176:179], v11 offset:17408
    ds_read_b64_tr_b16 v[192:193], v6 offset:8704
    ds_read_b64_tr_b16 v[194:195], v6 offset:10752
    s_add_u32 m0, s30, 8192
    s_nop 0
    buffer_load_dwordx4 v3, s[48:51], s29 offen lds
    s_add_u32 s29, s29, 8192
    s_waitcnt lgkmcnt(5)
    v_mfma_f32_32x32x16_bf16 v[128:143], v[180:183], v[100:103], v[128:143]
    v_add_f32 v8, v8, v208
    v_add_f32 v9, v9, v209
    v_cvt_pk_bf16_f32 v164, v208, v209
    v_exp_f32 v210, v122
    v_exp_f32 v211, v123
    ds_read_b128 v[180:183], v11 offset:17536
    ds_read_b64_tr_b16 v[196:197], v6 offset:8960
    ds_read_b64_tr_b16 v[198:199], v6 offset:11008
    s_waitcnt lgkmcnt(7)
    v_mfma_f32_32x32x16_bf16 v[128:143], v[184:187], v[104:107], v[128:143]
    v_add_f32 v8, v8, v210
    v_add_f32 v9, v9, v211
    v_cvt_pk_bf16_f32 v165, v210, v211
    v_exp_f32 v208, v124
    v_exp_f32 v209, v125
    ds_read_b128 v[184:187], v11 offset:17664
    ds_read_b64_tr_b16 v[200:201], v6 offset:9216
    ds_read_b64_tr_b16 v[202:203], v6 offset:11264
    buffer_load_dwordx4 v[212:215], v10, s[52:55], s101 offen
    s_add_u32 s101, s101, 7168
    s_waitcnt lgkmcnt(9)
    v_mfma_f32_32x32x16_bf16 v[128:143], v[188:191], v[108:111], v[128:143]
    v_add_f32 v8, v8, v208
    v_add_f32 v9, v9, v209
    v_cvt_pk_bf16_f32 v166, v208, v209
    v_exp_f32 v210, v126
    v_exp_f32 v211, v127
    ds_read_b128 v[188:191], v11 offset:17792
    ds_read_b64_tr_b16 v[204:205], v6 offset:9472
    ds_read_b64_tr_b16 v[206:207], v6 offset:11520
    s_waitcnt lgkmcnt(11)
    v_mfma_f32_32x32x16_bf16 v[112:127], v[176:179], v[80:83], v[144:159]
    v_add_f32 v8, v8, v210
    v_add_f32 v9, v9, v211
    v_cvt_pk_bf16_f32 v167, v210, v211
    s_waitcnt lgkmcnt(9)
    v_mfma_f32_32x32x16_bf16 v[16:31], v[192:195], v[160:163], 0
    v_exp_f32 v208, v128
    v_exp_f32 v209, v129
    ds_read_b128 v[176:179], v11 offset:17920
    ds_read_b64_tr_b16 v[192:193], v6 offset:12800
    ds_read_b64_tr_b16 v[194:195], v6 offset:14848
    s_add_u32 m0, s30, 16384
    s_nop 0
    buffer_load_dwordx4 v3, s[48:51], s29 offen lds
    s_add_u32 s29, s29, 8192
    s_waitcnt lgkmcnt(11)
    v_mfma_f32_32x32x16_bf16 v[112:127], v[180:183], v[84:87], v[112:127]
    v_add_f32 v8, v8, v208
    v_add_f32 v9, v9, v209
    v_cvt_pk_bf16_f32 v168, v208, v209
    s_waitcnt lgkmcnt(9)
    v_mfma_f32_32x32x16_bf16 v[32:47], v[196:199], v[160:163], 0
    v_exp_f32 v210, v130
    v_exp_f32 v211, v131
    ds_read_b128 v[180:183], v11 offset:18048
    ds_read_b64_tr_b16 v[196:197], v6 offset:13056
    ds_read_b64_tr_b16 v[198:199], v6 offset:15104
    s_waitcnt lgkmcnt(11)
    v_mfma_f32_32x32x16_bf16 v[112:127], v[184:187], v[88:91], v[112:127]
    v_add_f32 v8, v8, v210
    v_add_f32 v9, v9, v211
    v_cvt_pk_bf16_f32 v169, v210, v211
    s_waitcnt lgkmcnt(9)
    v_mfma_f32_32x32x16_bf16 v[48:63], v[200:203], v[160:163], 0
    v_exp_f32 v208, v132
    v_exp_f32 v209, v133
    ds_read_b128 v[184:187], v11 offset:18176
    ds_read_b64_tr_b16 v[200:201], v6 offset:13312
    ds_read_b64_tr_b16 v[202:203], v6 offset:15360
    s_waitcnt lgkmcnt(11)
    v_mfma_f32_32x32x16_bf16 v[112:127], v[188:191], v[92:95], v[112:127]
    v_add_f32 v8, v8, v208
    v_add_f32 v9, v9, v209
    v_cvt_pk_bf16_f32 v170, v208, v209
    s_waitcnt lgkmcnt(9)
    v_mfma_f32_32x32x16_bf16 v[64:79], v[204:207], v[160:163], 0
    v_exp_f32 v210, v134
    v_exp_f32 v211, v135
    ds_read_b128 v[188:191], v11 offset:18304
    ds_read_b64_tr_b16 v[204:205], v6 offset:13568
    ds_read_b64_tr_b16 v[206:207], v6 offset:15616
    s_add_u32 m0, s30, 24576
    s_nop 0
    buffer_load_dwordx4 v3, s[48:51], s29 offen lds
    s_add_u32 s29, s29, 8192
    s_waitcnt lgkmcnt(11)
    v_mfma_f32_32x32x16_bf16 v[112:127], v[176:179], v[96:99], v[112:127]
    v_add_f32 v8, v8, v210
    v_add_f32 v9, v9, v211
    v_cvt_pk_bf16_f32 v171, v210, v211
    s_waitcnt lgkmcnt(9)
    v_mfma_f32_32x32x16_bf16 v[16:31], v[192:195], v[164:167], v[16:31]
    v_exp_f32 v208, v136
    v_exp_f32 v209, v137
    ds_read_b128 v[176:179], v4 offset:0
    ds_read_b64_tr_b16 v[192:193], v6 offset:16896
    ds_read_b64_tr_b16 v[194:195], v6 offset:18944
    s_waitcnt lgkmcnt(11)
    v_mfma_f32_32x32x16_bf16 v[112:127], v[180:183], v[100:103], v[112:127]
    v_add_f32 v8, v8, v208
    v_add_f32 v9, v9, v209
    v_cvt_pk_bf16_f32 v172, v208, v209
    s_waitcnt lgkmcnt(9)
    v_mfma_f32_32x32x16_bf16 v[32:47], v[196:199], v[164:167], v[32:47]
    v_exp_f32 v210, v138
    v_exp_f32 v211, v139
    ds_read_b128 v[180:183], v4 offset:128
    ds_read_b64_tr_b16 v[196:197], v6 offset:17152
    ds_read_b64_tr_b16 v[198:199], v6 offset:19200
    s_waitcnt lgkmcnt(11)
    v_mfma_f32_32x32x16_bf16 v[112:127], v[184:187], v[104:107], v[112:127]
    v_add_f32 v8, v8, v210
    v_add_f32 v9, v9, v211
    v_cvt_pk_bf16_f32 v173, v210, v211
    s_waitcnt lgkmcnt(9)
    v_mfma_f32_32x32x16_bf16 v[48:63], v[200:203], v[164:167], v[48:63]
    v_exp_f32 v208, v140
    v_exp_f32 v209, v141
    ds_read_b128 v[184:187], v4 offset:256
    ds_read_b64_tr_b16 v[200:201], v6 offset:17408
    ds_read_b64_tr_b16 v[202:203], v6 offset:19456
    buffer_load_dwordx4 v[216:219], v10, s[52:55], s101 offen
    s_add_u32 s101, s101, 7168
    s_waitcnt lgkmcnt(11)
    v_mfma_f32_32x32x16_bf16 v[112:127], v[188:191], v[108:111], v[112:127]
    v_add_f32 v8, v8, v208
    v_add_f32 v9, v9, v209
    v_cvt_pk_bf16_f32 v174, v208, v209
    s_waitcnt lgkmcnt(9)
    v_mfma_f32_32x32x16_bf16 v[64:79], v[204:207], v[164:167], v[64:79]
    v_exp_f32 v210, v142
    v_exp_f32 v211, v143
    ds_read_b128 v[188:191], v4 offset:384
    ds_read_b64_tr_b16 v[204:205], v6 offset:17664
    ds_read_b64_tr_b16 v[206:207], v6 offset:19712
    s_waitcnt vmcnt(5)
    s_barrier
    s_waitcnt lgkmcnt(11)
    v_mfma_f32_32x32x16_bf16 v[128:143], v[176:179], v[80:83], v[144:159]
    v_add_f32 v8, v8, v210
    v_add_f32 v9, v9, v211
    v_cvt_pk_bf16_f32 v175, v210, v211
    s_waitcnt lgkmcnt(9)
    v_mfma_f32_32x32x16_bf16 v[16:31], v[192:195], v[168:171], v[16:31]
    v_exp_f32 v208, v112
    v_exp_f32 v209, v113
    ds_read_b128 v[176:179], v4 offset:512
    ds_read_b64_tr_b16 v[192:193], v6 offset:20992
    ds_read_b64_tr_b16 v[194:195], v6 offset:23040
    s_add_u32 m0, s28, 139776
    s_nop 0
    buffer_load_dwordx4 v2, s[44:47], s27 offen lds
    s_add_u32 s27, s27, 8192
    s_waitcnt lgkmcnt(11)
    v_mfma_f32_32x32x16_bf16 v[128:143], v[180:183], v[84:87], v[128:143]
    v_add_f32 v8, v8, v208
    v_add_f32 v9, v9, v209
    v_cvt_pk_bf16_f32 v160, v208, v209
    s_waitcnt lgkmcnt(9)
    v_mfma_f32_32x32x16_bf16 v[32:47], v[196:199], v[168:171], v[32:47]
    v_exp_f32 v210, v114
    v_exp_f32 v211, v115
    ds_read_b128 v[180:183], v4 offset:640
    ds_read_b64_tr_b16 v[196:197], v6 offset:21248
    ds_read_b64_tr_b16 v[198:199], v6 offset:23296
    s_waitcnt lgkmcnt(11)
    v_mfma_f32_32x32x16_bf16 v[128:143], v[184:187], v[88:91], v[128:143]
    v_add_f32 v8, v8, v210
    v_add_f32 v9, v9, v211
    v_cvt_pk_bf16_f32 v161, v210, v211
    s_waitcnt lgkmcnt(9)
    v_mfma_f32_32x32x16_bf16 v[48:63], v[200:203], v[168:171], v[48:63]
    v_exp_f32 v208, v116
    v_exp_f32 v209, v117
    ds_read_b128 v[184:187], v4 offset:768
    ds_read_b64_tr_b16 v[200:201], v6 offset:21504
    ds_read_b64_tr_b16 v[202:203], v6 offset:23552
    s_add_u32 m0, s28, 148480
    s_nop 0
    buffer_load_dwordx4 v2, s[44:47], s27 offen lds
    s_add_u32 s27, s27, 8192
    s_waitcnt lgkmcnt(11)
    v_mfma_f32_32x32x16_bf16 v[128:143], v[188:191], v[92:95], v[128:143]
    v_add_f32 v8, v8, v208
    v_add_f32 v9, v9, v209
    v_cvt_pk_bf16_f32 v162, v208, v209
    s_waitcnt lgkmcnt(9)
    v_mfma_f32_32x32x16_bf16 v[64:79], v[204:207], v[168:171], v[64:79]
    v_exp_f32 v210, v118
    v_exp_f32 v211, v119
    ds_read_b128 v[188:191], v4 offset:896
    ds_read_b64_tr_b16 v[204:205], v6 offset:21760
    ds_read_b64_tr_b16 v[206:207], v6 offset:23808
    s_waitcnt lgkmcnt(11)
    v_mfma_f32_32x32x16_bf16 v[128:143], v[176:179], v[96:99], v[128:143]
    v_add_f32 v8, v8, v210
    v_add_f32 v9, v9, v211
    v_cvt_pk_bf16_f32 v163, v210, v211
    s_waitcnt lgkmcnt(9)
    v_mfma_f32_32x32x16_bf16 v[16:31], v[192:195], v[172:175], v[16:31]
    v_exp_f32 v208, v120
    v_exp_f32 v209, v121
    ds_read_b128 v[176:179], v4 offset:25088
    ds_read_b64_tr_b16 v[192:193], v6 offset:51200
    ds_read_b64_tr_b16 v[194:195], v6 offset:53248
    s_add_u32 m0, s30, 32768
    s_nop 0
    buffer_load_dwordx4 v3, s[48:51], s29 offen lds
    s_add_u32 s29, s29, 8192
    s_waitcnt lgkmcnt(11)
    v_mfma_f32_32x32x16_bf16 v[128:143], v[180:183], v[100:103], v[128:143]
    v_add_f32 v8, v8, v208
    v_add_f32 v9, v9, v209
    v_cvt_pk_bf16_f32 v164, v208, v209
    s_waitcnt lgkmcnt(9)
    v_mfma_f32_32x32x16_bf16 v[32:47], v[196:199], v[172:175], v[32:47]
    v_exp_f32 v210, v122
    v_exp_f32 v211, v123
    ds_read_b128 v[180:183], v4 offset:25216
    ds_read_b64_tr_b16 v[196:197], v6 offset:51456
    ds_read_b64_tr_b16 v[198:199], v6 offset:53504
    s_waitcnt lgkmcnt(11)
    v_mfma_f32_32x32x16_bf16 v[128:143], v[184:187], v[104:107], v[128:143]
    v_add_f32 v8, v8, v210
    v_add_f32 v9, v9, v211
    v_cvt_pk_bf16_f32 v165, v210, v211
    s_waitcnt lgkmcnt(9)
    v_mfma_f32_32x32x16_bf16 v[48:63], v[200:203], v[172:175], v[48:63]
    v_exp_f32 v208, v124
    v_exp_f32 v209, v125
    ds_read_b128 v[184:187], v4 offset:25344
    ds_read_b64_tr_b16 v[200:201], v6 offset:51712
    ds_read_b64_tr_b16 v[202:203], v6 offset:53760
    buffer_load_dwordx4 v[220:223], v10, s[52:55], s101 offen
    s_add_u32 s101, s101, 7168
    s_waitcnt lgkmcnt(11)
    v_mfma_f32_32x32x16_bf16 v[128:143], v[188:191], v[108:111], v[128:143]
    v_add_f32 v8, v8, v208
    v_add_f32 v9, v9, v209
    v_cvt_pk_bf16_f32 v166, v208, v209
    s_waitcnt lgkmcnt(9)
    v_mfma_f32_32x32x16_bf16 v[64:79], v[204:207], v[172:175], v[64:79]
    v_exp_f32 v210, v126
    v_exp_f32 v211, v127
    ds_read_b128 v[188:191], v4 offset:25472
    ds_read_b64_tr_b16 v[204:205], v6 offset:51968
    ds_read_b64_tr_b16 v[206:207], v6 offset:54016
    s_waitcnt lgkmcnt(11)
    v_mfma_f32_32x32x16_bf16 v[112:127], v[176:179], v[80:83], v[144:159]
    v_add_f32 v8, v8, v210
    v_add_f32 v9, v9, v211
    v_cvt_pk_bf16_f32 v167, v210, v211
    s_waitcnt lgkmcnt(9)
    v_mfma_f32_32x32x16_bf16 v[16:31], v[192:195], v[160:163], v[16:31]
    v_exp_f32 v208, v128
    v_exp_f32 v209, v129
    ds_read_b128 v[176:179], v4 offset:25600
    ds_read_b64_tr_b16 v[192:193], v6 offset:55296
    ds_read_b64_tr_b16 v[194:195], v6 offset:57344
    s_add_u32 m0, s30, 40960
    s_nop 0
    buffer_load_dwordx4 v3, s[48:51], s29 offen lds
    s_add_u32 s29, s29, 8192
    s_waitcnt lgkmcnt(11)
    v_mfma_f32_32x32x16_bf16 v[112:127], v[180:183], v[84:87], v[112:127]
    v_add_f32 v8, v8, v208
    v_add_f32 v9, v9, v209
    v_cvt_pk_bf16_f32 v168, v208, v209
    s_waitcnt lgkmcnt(9)
    v_mfma_f32_32x32x16_bf16 v[32:47], v[196:199], v[160:163], v[32:47]
    v_exp_f32 v210, v130
    v_exp_f32 v211, v131
    ds_read_b128 v[180:183], v4 offset:25728
    ds_read_b64_tr_b16 v[196:197], v6 offset:55552
    ds_read_b64_tr_b16 v[198:199], v6 offset:57600
    s_cmp_lg_u32 s3, 0
    s_cbranch_scc1 M_KL1
    v_lshlrev_b32 v14, 5, v1
    v_add_u32 v14, 4194304, v14
    global_load_dwordx4 v[244:247], v14, s[18:19] sc1
    global_load_dwordx4 v[248:251], v14, s[18:19] offset:16 sc1
M_KL1:
    s_waitcnt lgkmcnt(11)
    v_mfma_f32_32x32x16_bf16 v[112:127], v[184:187], v[88:91], v[112:127]
    v_add_f32 v8, v8, v210
    v_add_f32 v9, v9, v211
    v_cvt_pk_bf16_f32 v169, v210, v211
    s_waitcnt lgkmcnt(9)
    v_mfma_f32_32x32x16_bf16 v[48:63], v[200:203], v[160:163], v[48:63]
    v_exp_f32 v208, v132
    v_exp_f32 v209, v133
    ds_read_b128 v[184:187], v4 offset:25856
    ds_read_b64_tr_b16 v[200:201], v6 offset:55808
    ds_read_b64_tr_b16 v[202:203], v6 offset:57856
    s_add_u32 m0, s30, 49152
    s_nop 0
    buffer_load_dwordx4 v3, s[48:51], s29 offen lds
    s_add_u32 s29, s29, 8192
    s_waitcnt lgkmcnt(11)
    v_mfma_f32_32x32x16_bf16 v[112:127], v[188:191], v[92:95], v[112:127]
    v_add_f32 v8, v8, v208
    v_add_f32 v9, v9, v209
    v_cvt_pk_bf16_f32 v170, v208, v209
    s_waitcnt lgkmcnt(9)
    v_mfma_f32_32x32x16_bf16 v[64:79], v[204:207], v[160:163], v[64:79]
    v_exp_f32 v210, v134
    v_exp_f32 v211, v135
    ds_read_b128 v[188:191], v4 offset:25984
    ds_read_b64_tr_b16 v[204:205], v6 offset:56064
    ds_read_b64_tr_b16 v[206:207], v6 offset:58112
    s_waitcnt lgkmcnt(11)
    v_mfma_f32_32x32x16_bf16 v[112:127], v[176:179], v[96:99], v[112:127]
    v_add_f32 v8, v8, v210
    v_add_f32 v9, v9, v211
    v_cvt_pk_bf16_f32 v171, v210, v211
    s_waitcnt lgkmcnt(9)
    v_mfma_f32_32x32x16_bf16 v[16:31], v[192:195], v[164:167], v[16:31]
    v_exp_f32 v208, v136
    v_exp_f32 v209, v137
    ds_read_b128 v[176:179], v4 offset:33792
    ds_read_b64_tr_b16 v[192:193], v5 offset:0
    ds_read_b64_tr_b16 v[194:195], v5 offset:2048
    s_add_u32 m0, s30, 57344
    s_nop 0
    buffer_load_dwordx4 v3, s[48:51], s29 offen lds
    s_add_u32 s29, s29, 8192
    s_waitcnt lgkmcnt(11)
    v_mfma_f32_32x32x16_bf16 v[112:127], v[180:183], v[100:103], v[112:127]
    v_add_f32 v8, v8, v208
    v_add_f32 v9, v9, v209
    v_cvt_pk_bf16_f32 v172, v208, v209
    s_waitcnt lgkmcnt(9)
    v_mfma_f32_32x32x16_bf16 v[32:47], v[196:199], v[164:167], v[32:47]
    v_exp_f32 v210, v138
    v_exp_f32 v211, v139
    ds_read_b128 v[180:183], v4 offset:33920
    ds_read_b64_tr_b16 v[196:197], v5 offset:256
    ds_read_b64_tr_b16 v[198:199], v5 offset:2304
    s_waitcnt lgkmcnt(11)
    v_mfma_f32_32x32x16_bf16 v[112:127], v[184:187], v[104:107], v[112:127]
    v_add_f32 v8, v8, v210
    v_add_f32 v9, v9, v211
    v_cvt_pk_bf16_f32 v173, v210, v211
    s_waitcnt lgkmcnt(9)
    v_mfma_f32_32x32x16_bf16 v[48:63], v[200:203], v[164:167], v[48:63]
    v_exp_f32 v208, v140
    v_exp_f32 v209, v141
    ds_read_b128 v[184:187], v4 offset:34048
    ds_read_b64_tr_b16 v[200:201], v5 offset:512
    ds_read_b64_tr_b16 v[202:203], v5 offset:2560
    buffer_load_dwordx4 v[224:227], v10, s[52:55], s101 offen
    s_add_u32 s101, s101, 7168
    s_waitcnt lgkmcnt(11)
    v_mfma_f32_32x32x16_bf16 v[112:127], v[188:191], v[108:111], v[112:127]
    v_add_f32 v8, v8, v208
    v_add_f32 v9, v9, v209
    v_cvt_pk_bf16_f32 v174, v208, v209
    s_waitcnt lgkmcnt(9)
    v_mfma_f32_32x32x16_bf16 v[64:79], v[204:207], v[164:167], v[64:79]
    v_exp_f32 v210, v142
    v_exp_f32 v211, v143
    ds_read_b128 v[188:191], v4 offset:34176
    ds_read_b64_tr_b16 v[204:205], v5 offset:768
    ds_read_b64_tr_b16 v[206:207], v5 offset:2816
    s_waitcnt vmcnt(10)
    s_barrier
    s_waitcnt lgkmcnt(11)
    v_mfma_f32_32x32x16_bf16 v[128:143], v[176:179], v[80:83], v[144:159]
    v_add_f32 v8, v8, v210
    v_add_f32 v9, v9, v211
    v_cvt_pk_bf16_f32 v175, v210, v211
    s_waitcnt lgkmcnt(9)
    v_mfma_f32_32x32x16_bf16 v[16:31], v[192:195], v[168:171], v[16:31]
    v_exp_f32 v208, v112
    v_exp_f32 v209, v113
    ds_read_b128 v[176:179], v4 offset:34304
    ds_read_b64_tr_b16 v[192:193], v5 offset:4096
    ds_read_b64_tr_b16 v[194:195], v5 offset:6144
    s_add_u32 m0, s28, 65536
    s_nop 0
    buffer_load_dwordx4 v2, s[44:47], s27 offen lds
    s_add_u32 s27, s27, 8192
    s_waitcnt lgkmcnt(11)
    v_mfma_f32_32x32x16_bf16 v[128:143], v[180:183], v[84:87], v[128:143]
    v_add_f32 v8, v8, v208
    v_add_f32 v9, v9, v209
    v_cvt_pk_bf16_f32 v160, v208, v209
    s_waitcnt lgkmcnt(9)
    v_mfma_f32_32x32x16_bf16 v[32:47], v[196:199], v[168:171], v[32:47]
    v_exp_f32 v210, v114
    v_exp_f32 v211, v115
    ds_read_b128 v[180:183], v4 offset:34432
    ds_read_b64_tr_b16 v[196:197], v5 offset:4352
    ds_read_b64_tr_b16 v[198:199], v5 offset:6400
    s_waitcnt lgkmcnt(11)
    v_mfma_f32_32x32x16_bf16 v[128:143], v[184:187], v[88:91], v[128:143]
    v_add_f32 v8, v8, v210
    v_add_f32 v9, v9, v211
    v_cvt_pk_bf16_f32 v161, v210, v211
    s_waitcnt lgkmcnt(9)
    v_mfma_f32_32x32x16_bf16 v[48:63], v[200:203], v[168:171], v[48:63]
    v_exp_f32 v208, v116
    v_exp_f32 v209, v117
    ds_read_b128 v[184:187], v4 offset:34560
    ds_read_b64_tr_b16 v[200:201], v5 offset:4608
    ds_read_b64_tr_b16 v[202:203], v5 offset:6656
    s_add_u32 m0, s28, 90624
    s_nop 0
    buffer_load_dwordx4 v2, s[44:47], s27 offen lds
    s_add_u32 s27, s27, 8192
    s_waitcnt lgkmcnt(11)
    v_mfma_f32_32x32x16_bf16 v[128:143], v[188:191], v[92:95], v[128:143]
    v_add_f32 v8, v8, v208
    v_add_f32 v9, v9, v209
    v_cvt_pk_bf16_f32 v162, v208, v209
    s_waitcnt lgkmcnt(9)
    v_mfma_f32_32x32x16_bf16 v[64:79], v[204:207], v[168:171], v[64:79]
    v_exp_f32 v210, v118
    v_exp_f32 v211, v119
    ds_read_b128 v[188:191], v4 offset:34688
    ds_read_b64_tr_b16 v[204:205], v5 offset:4864
    ds_read_b64_tr_b16 v[206:207], v5 offset:6912
    s_waitcnt lgkmcnt(11)
    v_mfma_f32_32x32x16_bf16 v[128:143], v[176:179], v[96:99], v[128:143]
    v_add_f32 v8, v8, v210
    v_add_f32 v9, v9, v211
    v_cvt_pk_bf16_f32 v163, v210, v211
    s_waitcnt lgkmcnt(9)
    v_mfma_f32_32x32x16_bf16 v[16:31], v[192:195], v[172:175], v[16:31]
    v_exp_f32 v208, v120
    v_exp_f32 v209, v121
    ds_read_b128 v[176:179], v4 offset:42496
    ds_read_b64_tr_b16 v[192:193], v5 offset:8192
    ds_read_b64_tr_b16 v[194:195], v5 offset:10240
    s_add_u32 m0, s30, 74240
    s_nop 0
    buffer_load_dwordx4 v3, s[48:51], s29 offen lds
    s_add_u32 s29, s29, 8192
    s_waitcnt lgkmcnt(11)
    v_mfma_f32_32x32x16_bf16 v[128:143], v[180:183], v[100:103], v[128:143]
    v_add_f32 v8, v8, v208
    v_add_f32 v9, v9, v209
    v_cvt_pk_bf16_f32 v164, v208, v209
    s_waitcnt lgkmcnt(9)
    v_mfma_f32_32x32x16_bf16 v[32:47], v[196:199], v[172:175], v[32:47]
    v_exp_f32 v210, v122
    v_exp_f32 v211, v123
    ds_read_b128 v[180:183], v4 offset:42624
    ds_read_b64_tr_b16 v[196:197], v5 offset:8448
    ds_read_b64_tr_b16 v[198:199], v5 offset:10496
    s_waitcnt lgkmcnt(11)
    v_mfma_f32_32x32x16_bf16 v[128:143], v[184:187], v[104:107], v[128:143]
    v_add_f32 v8, v8, v210
    v_add_f32 v9, v9, v211
    v_cvt_pk_bf16_f32 v165, v210, v211
    s_waitcnt lgkmcnt(9)
    v_mfma_f32_32x32x16_bf16 v[48:63], v[200:203], v[172:175], v[48:63]
    v_exp_f32 v208, v124
    v_exp_f32 v209, v125
    ds_read_b128 v[184:187], v4 offset:42752
    ds_read_b64_tr_b16 v[200:201], v5 offset:8704
    ds_read_b64_tr_b16 v[202:203], v5 offset:10752
    buffer_load_dwordx4 v[228:231], v10, s[52:55], s101 offen
    s_add_u32 s101, s101, 7168
    s_waitcnt lgkmcnt(11)
    v_mfma_f32_32x32x16_bf16 v[128:143], v[188:191], v[108:111], v[128:143]
    v_add_f32 v8, v8, v208
    v_add_f32 v9, v9, v209
    v_cvt_pk_bf16_f32 v166, v208, v209
    s_waitcnt lgkmcnt(9)
    v_mfma_f32_32x32x16_bf16 v[64:79], v[204:207], v[172:175], v[64:79]
    v_exp_f32 v210, v126
    v_exp_f32 v211, v127
    ds_read_b128 v[188:191], v4 offset:42880
    ds_read_b64_tr_b16 v[204:205], v5 offset:8960
    ds_read_b64_tr_b16 v[206:207], v5 offset:11008
    s_waitcnt lgkmcnt(11)
    v_mfma_f32_32x32x16_bf16 v[112:127], v[176:179], v[80:83], v[144:159]
    v_add_f32 v8, v8, v210
    v_add_f32 v9, v9, v211
    v_cvt_pk_bf16_f32 v167, v210, v211
    s_waitcnt lgkmcnt(9)
    v_mfma_f32_32x32x16_bf16 v[16:31], v[192:195], v[160:163], v[16:31]
    v_exp_f32 v208, v128
    v_exp_f32 v209, v129
    ds_read_b128 v[176:179], v4 offset:43008
    ds_read_b64_tr_b16 v[192:193], v5 offset:12288
    ds_read_b64_tr_b16 v[194:195], v5 offset:14336
    s_add_u32 m0, s30, 82432
    s_nop 0
    buffer_load_dwordx4 v3, s[48:51], s29 offen lds
    s_add_u32 s29, s29, 8192
    s_waitcnt lgkmcnt(11)
    v_mfma_f32_32x32x16_bf16 v[112:127], v[180:183], v[84:87], v[112:127]
    v_add_f32 v8, v8, v208
    v_add_f32 v9, v9, v209
    v_cvt_pk_bf16_f32 v168, v208, v209
    s_waitcnt lgkmcnt(9)
    v_mfma_f32_32x32x16_bf16 v[32:47], v[196:199], v[160:163], v[32:47]
    v_exp_f32 v210, v130
    v_exp_f32 v211, v131
    ds_read_b128 v[180:183], v4 offset:43136
    ds_read_b64_tr_b16 v[196:197], v5 offset:12544
    ds_read_b64_tr_b16 v[198:199], v5 offset:14592
    s_waitcnt lgkmcnt(11)
    v_mfma_f32_32x32x16_bf16 v[112:127], v[184:187], v[88:91], v[112:127]
    v_add_f32 v8, v8, v210
    v_add_f32 v9, v9, v211
    v_cvt_pk_bf16_f32 v169, v210, v211
    s_waitcnt lgkmcnt(9)
    v_mfma_f32_32x32x16_bf16 v[48:63], v[200:203], v[160:163], v[48:63]
    v_exp_f32 v208, v132
    v_exp_f32 v209, v133
    ds_read_b128 v[184:187], v4 offset:43264
    ds_read_b64_tr_b16 v[200:201], v5 offset:12800
    ds_read_b64_tr_b16 v[202:203], v5 offset:14848
    s_waitcnt lgkmcnt(11)
    v_mfma_f32_32x32x16_bf16 v[112:127], v[188:191], v[92:95], v[112:127]
    v_add_f32 v8, v8, v208
    v_add_f32 v9, v9, v209
    v_cvt_pk_bf16_f32 v170, v208, v209
    s_waitcnt lgkmcnt(9)
    v_mfma_f32_32x32x16_bf16 v[64:79], v[204:207], v[160:163], v[64:79]
    v_exp_f32 v210, v134
    v_exp_f32 v211, v135
    ds_read_b128 v[188:191], v4 offset:43392
    ds_read_b64_tr_b16 v[204:205], v5 offset:13056
    ds_read_b64_tr_b16 v[206:207], v5 offset:15104
    s_add_u32 m0, s30, 116736
    s_nop 0
    buffer_load_dwordx4 v3, s[48:51], s29 offen lds
    s_add_u32 s29, s29, 8192
    s_waitcnt lgkmcnt(11)
    v_mfma_f32_32x32x16_bf16 v[112:127], v[176:179], v[96:99], v[112:127]
    v_add_f32 v8, v8, v210
    v_add_f32 v9, v9, v211
    v_cvt_pk_bf16_f32 v171, v210, v211
    s_waitcnt lgkmcnt(9)
    v_mfma_f32_32x32x16_bf16 v[16:31], v[192:195], v[164:167], v[16:31]
    v_exp_f32 v208, v136
    v_exp_f32 v209, v137
    ds_read_b128 v[176:179], v11 offset:0
    ds_read_b64_tr_b16 v[192:193], v5 offset:16384
    ds_read_b64_tr_b16 v[194:195], v5 offset:18432
    s_waitcnt lgkmcnt(11)
    v_mfma_f32_32x32x16_bf16 v[112:127], v[180:183], v[100:103], v[112:127]
    v_add_f32 v8, v8, v208
    v_add_f32 v9, v9, v209
    v_cvt_pk_bf16_f32 v172, v208, v209
    s_waitcnt lgkmcnt(9)
    v_mfma_f32_32x32x16_bf16 v[32:47], v[196:199], v[164:167], v[32:47]
    v_exp_f32 v210, v138
    v_exp_f32 v211, v139
    ds_read_b128 v[180:183], v11 offset:128
    ds_read_b64_tr_b16 v[196:197], v5 offset:16640
    ds_read_b64_tr_b16 v[198:199], v5 offset:18688
    s_cmp_lg_u32 s3, 0
    s_cbranch_scc1 M_KL2
    s_waitcnt vmcnt(9)
    v_xor_b32 v245, s33, v245
    v_xor_b32 v247, s33, v247
    v_xor_b32 v249, s33, v249
    v_xor_b32 v251, s33, v251
    v_or3_b32 v245, v245, v247, v249
    v_or_b32 v245, v245, v251
    v_cmp_ne_u32 vcc, 0, v245
    s_mov_b32 s73, 20000
    s_cbranch_vccnz M_KSPIN
M_KSPIN_RET:
    v_max3_u32 v244, v244, v246, v248
    v_max_u32 v244, v244, v250
    s_nop 1
    v_max_u32_dpp v244, v244, v244 quad_perm:[1,0,3,2] row_mask:0xf bank_mask:0xf
    s_nop 1
    v_max_u32_dpp v244, v244, v244 quad_perm:[2,3,0,1] row_mask:0xf bank_mask:0xf
    s_nop 1
    v_max_u32_dpp v244, v244, v244 row_half_mirror row_mask:0xf bank_mask:0xf
    s_nop 1
    v_max_u32_dpp v244, v244, v244 row_mirror row_mask:0xf bank_mask:0xf
    v_mov_b32 v245, v244
    s_nop 1
    v_permlane16_swap_b32 v244, v245
    v_max_u32 v244, v244, v245
    v_mov_b32 v245, v244
    s_nop 1
    v_permlane32_swap_b32 v244, v245
    v_max_u32 v244, v244, v245
    v_mov_b32 v245, 154944
    ds_write_b32 v245, v244
    s_waitcnt lgkmcnt(0)
M_KL2:
    s_waitcnt lgkmcnt(11)
    v_mfma_f32_32x32x16_bf16 v[112:127], v[184:187], v[104:107], v[112:127]
    v_add_f32 v8, v8, v210
    v_add_f32 v9, v9, v211
    v_cvt_pk_bf16_f32 v173, v210, v211
    s_waitcnt lgkmcnt(9)
    v_mfma_f32_32x32x16_bf16 v[48:63], v[200:203], v[164:167], v[48:63]
    v_exp_f32 v208, v140
    v_exp_f32 v209, v141
    ds_read_b128 v[184:187], v11 offset:256
    ds_read_b64_tr_b16 v[200:201], v5 offset:16896
    ds_read_b64_tr_b16 v[202:203], v5 offset:18944
    buffer_load_dwordx4 v[232:235], v10, s[52:55], s101 offen
    s_add_u32 s101, s101, 7168
    s_waitcnt lgkmcnt(11)
    v_mfma_f32_32x32x16_bf16 v[112:127], v[188:191], v[108:111], v[112:127]
    v_add_f32 v8, v8, v208
    v_add_f32 v9, v9, v209
    v_cvt_pk_bf16_f32 v174, v208, v209
    s_waitcnt lgkmcnt(9)
    v_mfma_f32_32x32x16_bf16 v[64:79], v[204:207], v[164:167], v[64:79]
    v_exp_f32 v210, v142
    v_exp_f32 v211, v143
    ds_read_b128 v[188:191], v11 offset:384
    ds_read_b64_tr_b16 v[204:205], v5 offset:17152
    ds_read_b64_tr_b16 v[206:207], v5 offset:19200
    s_waitcnt vmcnt(12)
    s_barrier
    s_waitcnt lgkmcnt(11)
    v_mfma_f32_32x32x16_bf16 v[128:143], v[176:179], v[80:83], v[144:159]
    v_add_f32 v8, v8, v210
    v_add_f32 v9, v9, v211
    v_cvt_pk_bf16_f32 v175, v210, v211
    s_waitcnt lgkmcnt(9)
    v_mfma_f32_32x32x16_bf16 v[16:31], v[192:195], v[168:171], v[16:31]
    v_exp_f32 v208, v112
    v_exp_f32 v209, v113
    ds_read_b128 v[176:179], v11 offset:512
    ds_read_b64_tr_b16 v[192:193], v5 offset:20480
    ds_read_b64_tr_b16 v[194:195], v5 offset:22528
    s_add_u32 m0, s28, 99328
    s_nop 0
    buffer_load_dwordx4 v2, s[44:47], s27 offen lds
    s_add_u32 s27, s27, 8192
    s_waitcnt lgkmcnt(11)
    v_mfma_f32_32x32x16_bf16 v[128:143], v[180:183], v[84:87], v[128:143]
    v_add_f32 v8, v8, v208
    v_add_f32 v9, v9, v209
    v_cvt_pk_bf16_f32 v160, v208, v209
    s_waitcnt lgkmcnt(9)
    v_mfma_f32_32x32x16_bf16 v[32:47], v[196:199], v[168:171], v[32:47]
    v_exp_f32 v210, v114
    v_exp_f32 v211, v115
    ds_read_b128 v[180:183], v11 offset:640
    ds_read_b64_tr_b16 v[196:197], v5 offset:20736
    ds_read_b64_tr_b16 v[198:199], v5 offset:22784
    v_mov_b32 v245, 154944
    ds_read_b32 v244, v245
    s_waitcnt lgkmcnt(12)
    v_mfma_f32_32x32x16_bf16 v[128:143], v[184:187], v[88:91], v[128:143]
    v_add_f32 v8, v8, v210
    v_add_f32 v9, v9, v211
    v_cvt_pk_bf16_f32 v161, v210, v211
    s_waitcnt lgkmcnt(10)
    v_mfma_f32_32x32x16_bf16 v[48:63], v[200:203], v[168:171], v[48:63]
    v_exp_f32 v208, v116
    v_exp_f32 v209, v117
    ds_read_b128 v[184:187], v11 offset:768
    ds_read_b64_tr_b16 v[200:201], v5 offset:20992
    ds_read_b64_tr_b16 v[202:203], v5 offset:23040
    s_add_u32 m0, s28, 108032
    s_nop 0
    buffer_load_dwordx4 v2, s[44:47], s27 offen lds
    s_add_u32 s27, s27, 8192
    s_waitcnt lgkmcnt(12)
    v_mfma_f32_32x32x16_bf16 v[128:143], v[188:191], v[92:95], v[128:143]
    v_add_f32 v8, v8, v208
    v_add_f32 v9, v9, v209
    v_cvt_pk_bf16_f32 v162, v208, v209
    s_waitcnt lgkmcnt(10)
    v_mfma_f32_32x32x16_bf16 v[64:79], v[204:207], v[168:171], v[64:79]
    v_exp_f32 v210, v118
    v_exp_f32 v211, v119
    ds_read_b128 v[188:191], v11 offset:896
    ds_read_b64_tr_b16 v[204:205], v5 offset:21248
    ds_read_b64_tr_b16 v[206:207], v5 offset:23296
    s_waitcnt lgkmcnt(6)
    v_readfirstlane_b32 s34, v244
    s_nop 0
    s_and_b32 s35, s34, 0x7ff
    s_sub_u32 s35, 2047, s35
    s_lshr_b32 s60, s35, 4
    s_lshl_b32 s60, s60, 15
    s_and_b32 s61, s2, 3
    s_lshl_b32 s61, s61, 13
    s_add_u32 s60, s60, s61
    s_lshl_b32 s61, s3, 10
    s_add_u32 s60, s60, s61
    s_and_b32 s61, s35, 15
    s_lshl_b32 s61, s61, 4
    s_add_u32 s60, s60, s61
    v_lshrrev_b32 v14, 4, v1
    v_lshlrev_b32 v14, 8, v14
    v_add_u32 v14, s60, v14
    global_load_dwordx4 v[252:255], v14, s[18:19] sc1
    v_mfma_f32_32x32x16_bf16 v[128:143], v[176:179], v[96:99], v[128:143]
    v_add_f32 v8, v8, v210
    v_add_f32 v9, v9, v211
    v_cvt_pk_bf16_f32 v163, v210, v211
    v_mfma_f32_32x32x16_bf16 v[16:31], v[192:195], v[172:175], v[16:31]
    v_exp_f32 v208, v120
    v_exp_f32 v209, v121
    ds_read_b128 v[176:179], v11 offset:8704
    ds_read_b64_tr_b16 v[192:193], v5 offset:24576
    ds_read_b64_tr_b16 v[194:195], v5 offset:26624
    s_add_u32 m0, s30, 0
    s_nop 0
    buffer_load_dwordx4 v3, s[48:51], s29 offen lds
    s_add_u32 s29, s29, 8192
    v_mfma_f32_32x32x16_bf16 v[128:143], v[180:183], v[100:103], v[128:143]
    v_add_f32 v8, v8, v208
    v_add_f32 v9, v9, v209
    v_cvt_pk_bf16_f32 v164, v208, v209
    v_mfma_f32_32x32x16_bf16 v[32:47], v[196:199], v[172:175], v[32:47]
    v_exp_f32 v210, v122
    v_exp_f32 v211, v123
    ds_read_b128 v[180:183], v11 offset:8832
    ds_read_b64_tr_b16 v[196:197], v5 offset:24832
    ds_read_b64_tr_b16 v[198:199], v5 offset:26880
    s_waitcnt lgkmcnt(11)
    v_mfma_f32_32x32x16_bf16 v[128:143], v[184:187], v[104:107], v[128:143]
    v_add_f32 v8, v8, v210
    v_add_f32 v9, v9, v211
    v_cvt_pk_bf16_f32 v165, v210, v211
    s_waitcnt lgkmcnt(9)
    v_mfma_f32_32x32x16_bf16 v[48:63], v[200:203], v[172:175], v[48:63]
    v_exp_f32 v208, v124
    v_exp_f32 v209, v125
    ds_read_b128 v[184:187], v11 offset:8960
    ds_read_b64_tr_b16 v[200:201], v5 offset:25088
    ds_read_b64_tr_b16 v[202:203], v5 offset:27136
    buffer_load_dwordx4 v[236:239], v10, s[52:55], s101 offen
    s_add_u32 s101, s101, 7168
    s_waitcnt lgkmcnt(11)
    v_mfma_f32_32x32x16_bf16 v[128:143], v[188:191], v[108:111], v[128:143]
    v_add_f32 v8, v8, v208
    v_add_f32 v9, v9, v209
    v_cvt_pk_bf16_f32 v166, v208, v209
    s_waitcnt lgkmcnt(9)
    v_mfma_f32_32x32x16_bf16 v[64:79], v[204:207], v[172:175], v[64:79]
    v_exp_f32 v210, v126
    v_exp_f32 v211, v127
    ds_read_b128 v[188:191], v11 offset:9088
    ds_read_b64_tr_b16 v[204:205], v5 offset:25344
    ds_read_b64_tr_b16 v[206:207], v5 offset:27392
    s_waitcnt lgkmcnt(11)
    v_mfma_f32_32x32x16_bf16 v[112:127], v[176:179], v[80:83], v[144:159]
    v_add_f32 v8, v8, v210
    v_add_f32 v9, v9, v211
    v_cvt_pk_bf16_f32 v167, v210, v211
    s_waitcnt lgkmcnt(9)
    v_mfma_f32_32x32x16_bf16 v[16:31], v[192:195], v[160:163], v[16:31]
    v_exp_f32 v208, v128
    v_exp_f32 v209, v129
    ds_read_b128 v[176:179], v11 offset:9216
    ds_read_b64_tr_b16 v[192:193], v5 offset:28672
    ds_read_b64_tr_b16 v[194:195], v5 offset:30720
    s_add_u32 m0, s30, 8192
    s_nop 0
    buffer_load_dwordx4 v3, s[48:51], s29 offen lds
    s_add_u32 s29, s29, 8192
    s_waitcnt lgkmcnt(11)
    v_mfma_f32_32x32x16_bf16 v[112:127], v[180:183], v[84:87], v[112:127]
    v_add_f32 v8, v8, v208
    v_add_f32 v9, v9, v209
    v_cvt_pk_bf16_f32 v168, v208, v209
    s_waitcnt lgkmcnt(9)
    v_mfma_f32_32x32x16_bf16 v[32:47], v[196:199], v[160:163], v[32:47]
    v_exp_f32 v210, v130
    v_exp_f32 v211, v131
    ds_read_b128 v[180:183], v11 offset:9344
    ds_read_b64_tr_b16 v[196:197], v5 offset:28928
    ds_read_b64_tr_b16 v[198:199], v5 offset:30976
    s_waitcnt lgkmcnt(11)
    v_mfma_f32_32x32x16_bf16 v[112:127], v[184:187], v[88:91], v[112:127]
    v_add_f32 v8, v8, v210
    v_add_f32 v9, v9, v211
    v_cvt_pk_bf16_f32 v169, v210, v211
    s_waitcnt lgkmcnt(9)
    v_mfma_f32_32x32x16_bf16 v[48:63], v[200:203], v[160:163], v[48:63]
    v_exp_f32 v208, v132
    v_exp_f32 v209, v133
    ds_read_b128 v[184:187], v11 offset:9472
    ds_read_b64_tr_b16 v[200:201], v5 offset:29184
    ds_read_b64_tr_b16 v[202:203], v5 offset:31232
    s_waitcnt lgkmcnt(11)
    v_mfma_f32_32x32x16_bf16 v[112:127], v[188:191], v[92:95], v[112:127]
    v_add_f32 v8, v8, v208
    v_add_f32 v9, v9, v209
    v_cvt_pk_bf16_f32 v170, v208, v209
    s_waitcnt lgkmcnt(9)
    v_mfma_f32_32x32x16_bf16 v[64:79], v[204:207], v[160:163], v[64:79]
    v_exp_f32 v210, v134
    v_exp_f32 v211, v135
    ds_read_b128 v[188:191], v11 offset:9600
    ds_read_b64_tr_b16 v[204:205], v5 offset:29440
    ds_read_b64_tr_b16 v[206:207], v5 offset:31488
    s_waitcnt lgkmcnt(11)
    v_mfma_f32_32x32x16_bf16 v[112:127], v[176:179], v[96:99], v[112:127]
    v_add_f32 v8, v8, v210
    v_add_f32 v9, v9, v211
    v_cvt_pk_bf16_f32 v171, v210, v211
    s_waitcnt lgkmcnt(9)
    v_mfma_f32_32x32x16_bf16 v[16:31], v[192:195], v[164:167], v[16:31]
    v_exp_f32 v208, v136
    v_exp_f32 v209, v137
    ds_read_b128 v[176:179], v11 offset:17408
    ds_read_b64_tr_b16 v[192:193], v5 offset:32768
    ds_read_b64_tr_b16 v[194:195], v5 offset:34816
    s_waitcnt lgkmcnt(11)
    v_mfma_f32_32x32x16_bf16 v[112:127], v[180:183], v[100:103], v[112:127]
    v_add_f32 v8, v8, v208
    v_add_f32 v9, v9, v209
    v_cvt_pk_bf16_f32 v172, v208, v209
    s_waitcnt lgkmcnt(9)
    v_mfma_f32_32x32x16_bf16 v[32:47], v[196:199], v[164:167], v[32:47]
    v_exp_f32 v210, v138
    v_exp_f32 v211, v139
    ds_read_b128 v[180:183], v11 offset:17536
    ds_read_b64_tr_b16 v[196:197], v5 offset:33024
    ds_read_b64_tr_b16 v[198:199], v5 offset:35072
    s_waitcnt lgkmcnt(11)
    v_mfma_f32_32x32x16_bf16 v[112:127], v[184:187], v[104:107], v[112:127]
    v_add_f32 v8, v8, v210
    v_add_f32 v9, v9, v211
    v_cvt_pk_bf16_f32 v173, v210, v211
    s_waitcnt lgkmcnt(9)
    v_mfma_f32_32x32x16_bf16 v[48:63], v[200:203], v[164:167], v[48:63]
    v_exp_f32 v208, v140
    v_exp_f32 v209, v141
    ds_read_b128 v[184:187], v11 offset:17664
    ds_read_b64_tr_b16 v[200:201], v5 offset:33280
    ds_read_b64_tr_b16 v[202:203], v5 offset:35328
    buffer_load_dwordx4 v[240:243], v10, s[52:55], s101 offen
    s_add_u32 s101, s101, 7168
    s_waitcnt lgkmcnt(11)
    v_mfma_f32_32x32x16_bf16 v[112:127], v[188:191], v[108:111], v[112:127]
    v_add_f32 v8, v8, v208
    v_add_f32 v9, v9, v209
    v_cvt_pk_bf16_f32 v174, v208, v209
    s_waitcnt lgkmcnt(9)
    v_mfma_f32_32x32x16_bf16 v[64:79], v[204:207], v[164:167], v[64:79]
    v_exp_f32 v210, v142
    v_exp_f32 v211, v143
    ds_read_b128 v[188:191], v11 offset:17792
    ds_read_b64_tr_b16 v[204:205], v5 offset:33536
    ds_read_b64_tr_b16 v[206:207], v5 offset:35584
    s_waitcnt vmcnt(12)
    s_barrier
    s_waitcnt lgkmcnt(11)
    v_mfma_f32_32x32x16_bf16 v[128:143], v[176:179], v[80:83], v[144:159]
    v_add_f32 v8, v8, v210
    v_add_f32 v9, v9, v211
    v_cvt_pk_bf16_f32 v175, v210, v211
    s_waitcnt lgkmcnt(9)
    v_mfma_f32_32x32x16_bf16 v[16:31], v[192:195], v[168:171], v[16:31]
    v_exp_f32 v208, v112
    v_exp_f32 v209, v113
    ds_read_b128 v[176:179], v11 offset:17920
    ds_read_b64_tr_b16 v[192:193], v5 offset:36864
    ds_read_b64_tr_b16 v[194:195], v5 offset:38912
    s_add_u32 m0, s28, 131072
    s_nop 0
    buffer_load_dwordx4 v2, s[44:47], s27 offen lds
    s_add_u32 s27, s27, 8192
    s_waitcnt lgkmcnt(11)
    v_mfma_f32_32x32x16_bf16 v[128:143], v[180:183], v[84:87], v[128:143]
    v_add_f32 v8, v8, v208
    v_add_f32 v9, v9, v209
    v_cvt_pk_bf16_f32 v160, v208, v209
    s_waitcnt lgkmcnt(9)
    v_mfma_f32_32x32x16_bf16 v[32:47], v[196:199], v[168:171], v[32:47]
    v_exp_f32 v210, v114
    v_exp_f32 v211, v115
    ds_read_b128 v[180:183], v11 offset:18048
    ds_read_b64_tr_b16 v[196:197], v5 offset:37120
    ds_read_b64_tr_b16 v[198:199], v5 offset:39168
    s_waitcnt lgkmcnt(11)
    v_mfma_f32_32x32x16_bf16 v[128:143], v[184:187], v[88:91], v[128:143]
    v_add_f32 v8, v8, v210
    v_add_f32 v9, v9, v211
    v_cvt_pk_bf16_f32 v161, v210, v211
    s_waitcnt lgkmcnt(9)
    v_mfma_f32_32x32x16_bf16 v[48:63], v[200:203], v[168:171], v[48:63]
    v_exp_f32 v208, v116
    v_exp_f32 v209, v117
    ds_read_b128 v[184:187], v11 offset:18176
    ds_read_b64_tr_b16 v[200:201], v5 offset:37376
    ds_read_b64_tr_b16 v[202:203], v5 offset:39424
    s_add_u32 m0, s28, 139776
    s_nop 0
    buffer_load_dwordx4 v2, s[44:47], s27 offen lds
    s_add_u32 s27, s27, 8192
    s_waitcnt lgkmcnt(11)
    v_mfma_f32_32x32x16_bf16 v[128:143], v[188:191], v[92:95], v[128:143]
    v_add_f32 v8, v8, v208
    v_add_f32 v9, v9, v209
    v_cvt_pk_bf16_f32 v162, v208, v209
    s_waitcnt lgkmcnt(9)
    v_mfma_f32_32x32x16_bf16 v[64:79], v[204:207], v[168:171], v[64:79]
    v_exp_f32 v210, v118
    v_exp_f32 v211, v119
    ds_read_b128 v[188:191], v11 offset:18304
    ds_read_b64_tr_b16 v[204:205], v5 offset:37632
    ds_read_b64_tr_b16 v[206:207], v5 offset:39680
    s_waitcnt lgkmcnt(11)
    v_mfma_f32_32x32x16_bf16 v[128:143], v[176:179], v[96:99], v[128:143]
    v_add_f32 v8, v8, v210
    v_add_f32 v9, v9, v211
    v_cvt_pk_bf16_f32 v163, v210, v211
    s_waitcnt lgkmcnt(9)
    v_mfma_f32_32x32x16_bf16 v[16:31], v[192:195], v[172:175], v[16:31]
    v_exp_f32 v208, v120
    v_exp_f32 v209, v121
    ds_read_b128 v[176:179], v4 offset:0
    ds_read_b64_tr_b16 v[192:193], v5 offset:40960
    ds_read_b64_tr_b16 v[194:195], v5 offset:43008
    s_waitcnt lgkmcnt(11)
    v_mfma_f32_32x32x16_bf16 v[128:143], v[180:183], v[100:103], v[128:143]
    v_add_f32 v8, v8, v208
    v_add_f32 v9, v9, v209
    v_cvt_pk_bf16_f32 v164, v208, v209
    s_waitcnt lgkmcnt(9)
    v_mfma_f32_32x32x16_bf16 v[32:47], v[196:199], v[172:175], v[32:47]
    v_exp_f32 v210, v122
    v_exp_f32 v211, v123
    ds_read_b128 v[180:183], v4 offset:128
    ds_read_b64_tr_b16 v[196:197], v5 offset:41216
    ds_read_b64_tr_b16 v[198:199], v5 offset:43264
    s_and_b32 s60, s2, 1
    s_lshl_b32 s60, s60, 2
    s_bfe_u32 s61, s2, 0x20001
    s_add_u32 s60, s60, s61
    s_lshl_b32 s60, s60, 5
    s_lshr_b32 s61, s2, 3
    s_add_u32 s60, s60, s61
    s_lshl_b32 s60, s60, 15
    s_add_u32 s68, s10, s60
    s_addc_u32 s69, s11, 0
    s_mov_b32 s70, 0x8000
    s_mov_b32 s71, 0x20000
    s_mov_b32 s72, 0
    s_add_u32 m0, s30, 16384
    v_lshlrev_b32 v15, 4, v0
    buffer_load_dwordx4 v15, s[68:71], s72 offen lds
    s_add_u32 s72, s72, 8192
    s_waitcnt lgkmcnt(11)
    v_mfma_f32_32x32x16_bf16 v[128:143], v[184:187], v[104:107], v[128:143]
    v_add_f32 v8, v8, v210
    v_add_f32 v9, v9, v211
    v_cvt_pk_bf16_f32 v165, v210, v211
    s_waitcnt lgkmcnt(9)
    v_mfma_f32_32x32x16_bf16 v[48:63], v[200:203], v[172:175], v[48:63]
    v_exp_f32 v208, v124
    v_exp_f32 v209, v125
    ds_read_b128 v[184:187], v4 offset:256
    ds_read_b64_tr_b16 v[200:201], v5 offset:41472
    ds_read_b64_tr_b16 v[202:203], v5 offset:43520
    s_waitcnt lgkmcnt(11)
    v_mfma_f32_32x32x16_bf16 v[128:143], v[188:191], v[108:111], v[128:143]
    v_add_f32 v8, v8, v208
    v_add_f32 v9, v9, v209
    v_cvt_pk_bf16_f32 v166, v208, v209
    s_waitcnt lgkmcnt(9)
    v_mfma_f32_32x32x16_bf16 v[64:79], v[204:207], v[172:175], v[64:79]
    v_exp_f32 v210, v126
    v_exp_f32 v211, v127
    ds_read_b128 v[188:191], v4 offset:384
    ds_read_b64_tr_b16 v[204:205], v5 offset:41728
    ds_read_b64_tr_b16 v[206:207], v5 offset:43776
    s_waitcnt lgkmcnt(11)
    v_mfma_f32_32x32x16_bf16 v[112:127], v[176:179], v[80:83], v[144:159]
    v_add_f32 v8, v8, v210
    v_add_f32 v9, v9, v211
    v_cvt_pk_bf16_f32 v167, v210, v211
    s_waitcnt lgkmcnt(9)
    v_mfma_f32_32x32x16_bf16 v[16:31], v[192:195], v[160:163], v[16:31]
    v_exp_f32 v208, v128
    v_exp_f32 v209, v129
    ds_read_b128 v[176:179], v4 offset:512
    ds_read_b64_tr_b16 v[192:193], v5 offset:45056
    ds_read_b64_tr_b16 v[194:195], v5 offset:47104
    s_waitcnt lgkmcnt(11)
    v_mfma_f32_32x32x16_bf16 v[112:127], v[180:183], v[84:87], v[112:127]
    v_add_f32 v8, v8, v208
    v_add_f32 v9, v9, v209
    v_cvt_pk_bf16_f32 v168, v208, v209
    s_waitcnt lgkmcnt(9)
    v_mfma_f32_32x32x16_bf16 v[32:47], v[196:199], v[160:163], v[32:47]
    v_exp_f32 v210, v130
    v_exp_f32 v211, v131
    ds_read_b128 v[180:183], v4 offset:640
    ds_read_b64_tr_b16 v[196:197], v5 offset:45312
    ds_read_b64_tr_b16 v[198:199], v5 offset:47360
    s_waitcnt lgkmcnt(11)
    v_mfma_f32_32x32x16_bf16 v[112:127], v[184:187], v[88:91], v[112:127]
    v_add_f32 v8, v8, v210
    v_add_f32 v9, v9, v211
    v_cvt_pk_bf16_f32 v169, v210, v211
    s_waitcnt lgkmcnt(9)
    v_mfma_f32_32x32x16_bf16 v[48:63], v[200:203], v[160:163], v[48:63]
    v_exp_f32 v208, v132
    v_exp_f32 v209, v133
    ds_read_b128 v[184:187], v4 offset:768
    ds_read_b64_tr_b16 v[200:201], v5 offset:45568
    ds_read_b64_tr_b16 v[202:203], v5 offset:47616
    s_waitcnt lgkmcnt(11)
    v_mfma_f32_32x32x16_bf16 v[112:127], v[188:191], v[92:95], v[112:127]
    v_add_f32 v8, v8, v208
    v_add_f32 v9, v9, v209
    v_cvt_pk_bf16_f32 v170, v208, v209
    s_waitcnt lgkmcnt(9)
    v_mfma_f32_32x32x16_bf16 v[64:79], v[204:207], v[160:163], v[64:79]
    v_exp_f32 v210, v134
    v_exp_f32 v211, v135
    ds_read_b128 v[188:191], v4 offset:896
    ds_read_b64_tr_b16 v[204:205], v5 offset:45824
    ds_read_b64_tr_b16 v[206:207], v5 offset:47872
    s_waitcnt lgkmcnt(11)
    v_mfma_f32_32x32x16_bf16 v[112:127], v[176:179], v[96:99], v[112:127]
    v_add_f32 v8, v8, v210
    v_add_f32 v9, v9, v211
    v_cvt_pk_bf16_f32 v171, v210, v211
    s_waitcnt lgkmcnt(9)
    v_mfma_f32_32x32x16_bf16 v[16:31], v[192:195], v[164:167], v[16:31]
    v_exp_f32 v208, v136
    v_exp_f32 v209, v137
    ds_read_b128 v[176:179], v4 offset:25088
    ds_read_b64_tr_b16 v[192:193], v5 offset:49152
    ds_read_b64_tr_b16 v[194:195], v5 offset:51200
    s_add_u32 m0, s30, 16384
    v_lshlrev_b32 v15, 4, v0
    buffer_load_dwordx4 v15, s[68:71], s72 offen lds
    s_add_u32 s72, s72, 8192
    s_waitcnt lgkmcnt(11)
    v_mfma_f32_32x32x16_bf16 v[112:127], v[180:183], v[100:103], v[112:127]
    v_add_f32 v8, v8, v208
    v_add_f32 v9, v9, v209
    v_cvt_pk_bf16_f32 v172, v208, v209
    s_waitcnt lgkmcnt(9)
    v_mfma_f32_32x32x16_bf16 v[32:47], v[196:199], v[164:167], v[32:47]
    v_exp_f32 v210, v138
    v_exp_f32 v211, v139
    ds_read_b128 v[180:183], v4 offset:25216
    ds_read_b64_tr_b16 v[196:197], v5 offset:49408
    ds_read_b64_tr_b16 v[198:199], v5 offset:51456
    s_waitcnt lgkmcnt(11)
    v_mfma_f32_32x32x16_bf16 v[112:127], v[184:187], v[104:107], v[112:127]
    v_add_f32 v8, v8, v210
    v_add_f32 v9, v9, v211
    v_cvt_pk_bf16_f32 v173, v210, v211
    s_waitcnt lgkmcnt(9)
    v_mfma_f32_32x32x16_bf16 v[48:63], v[200:203], v[164:167], v[48:63]
    v_exp_f32 v208, v140
    v_exp_f32 v209, v141
    ds_read_b128 v[184:187], v4 offset:25344
    ds_read_b64_tr_b16 v[200:201], v5 offset:49664
    ds_read_b64_tr_b16 v[202:203], v5 offset:51712
    s_waitcnt lgkmcnt(11)
    v_mfma_f32_32x32x16_bf16 v[112:127], v[188:191], v[108:111], v[112:127]
    v_add_f32 v8, v8, v208
    v_add_f32 v9, v9, v209
    v_cvt_pk_bf16_f32 v174, v208, v209
    s_waitcnt lgkmcnt(9)
    v_mfma_f32_32x32x16_bf16 v[64:79], v[204:207], v[164:167], v[64:79]
    v_exp_f32 v210, v142
    v_exp_f32 v211, v143
    ds_read_b128 v[188:191], v4 offset:25472
    ds_read_b64_tr_b16 v[204:205], v5 offset:49920
    ds_read_b64_tr_b16 v[206:207], v5 offset:51968
    s_waitcnt vmcnt(9)
    s_barrier
    s_waitcnt lgkmcnt(11)
    v_mfma_f32_32x32x16_bf16 v[128:143], v[176:179], v[80:83], v[144:159]
    v_add_f32 v8, v8, v210
    v_add_f32 v9, v9, v211
    v_cvt_pk_bf16_f32 v175, v210, v211
    s_waitcnt lgkmcnt(9)
    v_mfma_f32_32x32x16_bf16 v[16:31], v[192:195], v[168:171], v[16:31]
    v_exp_f32 v208, v112
    v_exp_f32 v209, v113
    ds_read_b128 v[176:179], v4 offset:25600
    ds_read_b64_tr_b16 v[192:193], v5 offset:53248
    ds_read_b64_tr_b16 v[194:195], v5 offset:55296
    s_waitcnt vmcnt(4)
    v_and_b32 v14, 15, v1
    v_lshlrev_b32 v14, 5, v14
    s_lshl_b32 s60, s3, 9
    s_add_u32 s60, s60, 159744
    v_add_u32 v14, s60, v14
    v_perm_b32 v244, v216, v212, s31
    v_perm_b32 v245, v224, v220, s31
    v_perm_b32 v246, v232, v228, s31
    v_perm_b32 v247, v240, v236, s31
    s_waitcnt lgkmcnt(11)
    v_mfma_f32_32x32x16_bf16 v[128:143], v[180:183], v[84:87], v[128:143]
    v_add_f32 v8, v8, v208
    v_add_f32 v9, v9, v209
    v_cvt_pk_bf16_f32 v160, v208, v209
    v_mfma_f32_16x16x32_bf16 v[248:251], v[252:255], v[244:247], 0
    s_waitcnt lgkmcnt(9)
    v_mfma_f32_32x32x16_bf16 v[32:47], v[196:199], v[168:171], v[32:47]
    v_exp_f32 v210, v114
    v_exp_f32 v211, v115
    ds_read_b128 v[180:183], v4 offset:25728
    ds_read_b64_tr_b16 v[196:197], v5 offset:53504
    ds_read_b64_tr_b16 v[198:199], v5 offset:55552
    s_nop 0
    ds_write_b32 v14, v248 offset:0
    v_perm_b32 v244, v216, v212, s32
    v_perm_b32 v245, v224, v220, s32
    v_perm_b32 v246, v232, v228, s32
    v_perm_b32 v247, v240, v236, s32
    s_waitcnt lgkmcnt(12)
    v_mfma_f32_32x32x16_bf16 v[128:143], v[184:187], v[88:91], v[128:143]
    v_add_f32 v8, v8, v210
    v_add_f32 v9, v9, v211
    v_cvt_pk_bf16_f32 v161, v210, v211
    v_mfma_f32_16x16x32_bf16 v[248:251], v[252:255], v[244:247], 0
    s_waitcnt lgkmcnt(10)
    v_mfma_f32_32x32x16_bf16 v[48:63], v[200:203], v[168:171], v[48:63]
    v_exp_f32 v208, v116
    v_exp_f32 v209, v117
    ds_read_b128 v[184:187], v4 offset:25856
    ds_read_b64_tr_b16 v[200:201], v5 offset:53760
    ds_read_b64_tr_b16 v[202:203], v5 offset:55808
    s_nop 0
    ds_write_b32 v14, v248 offset:4
    v_perm_b32 v244, v217, v213, s31
    v_perm_b32 v245, v225, v221, s31
    v_perm_b32 v246, v233, v229, s31
    v_perm_b32 v247, v241, v237, s31
    s_waitcnt lgkmcnt(13)
    v_mfma_f32_32x32x16_bf16 v[128:143], v[188:191], v[92:95], v[128:143]
    v_add_f32 v8, v8, v208
    v_add_f32 v9, v9, v209
    v_cvt_pk_bf16_f32 v162, v208, v209
    v_mfma_f32_16x16x32_bf16 v[248:251], v[252:255], v[244:247], 0
    s_waitcnt lgkmcnt(11)
    v_mfma_f32_32x32x16_bf16 v[64:79], v[204:207], v[168:171], v[64:79]
    v_exp_f32 v210, v118
    v_exp_f32 v211, v119
    ds_read_b128 v[188:191], v4 offset:25984
    ds_read_b64_tr_b16 v[204:205], v5 offset:54016
    ds_read_b64_tr_b16 v[206:207], v5 offset:56064
    s_nop 0
    ds_write_b32 v14, v248 offset:8
    v_perm_b32 v244, v217, v213, s32
    v_perm_b32 v245, v225, v221, s32
    v_perm_b32 v246, v233, v229, s32
    v_perm_b32 v247, v241, v237, s32
    s_waitcnt lgkmcnt(14)
    v_mfma_f32_32x32x16_bf16 v[128:143], v[176:179], v[96:99], v[128:143]
    v_add_f32 v8, v8, v210
    v_add_f32 v9, v9, v211
    v_cvt_pk_bf16_f32 v163, v210, v211
    v_mfma_f32_16x16x32_bf16 v[248:251], v[252:255], v[244:247], 0
    s_waitcnt lgkmcnt(12)
    v_mfma_f32_32x32x16_bf16 v[16:31], v[192:195], v[172:175], v[16:31]
    v_exp_f32 v208, v120
    v_exp_f32 v209, v121
    ds_read_b128 v[176:179], v4 offset:33792
    ds_read_b64_tr_b16 v[192:193], v5 offset:57344
    ds_read_b64_tr_b16 v[194:195], v5 offset:59392
    s_add_u32 m0, s30, 16384
    v_lshlrev_b32 v15, 4, v0
    buffer_load_dwordx4 v15, s[68:71], s72 offen lds
    s_add_u32 s72, s72, 8192
    ds_write_b32 v14, v248 offset:12
    v_perm_b32 v244, v218, v214, s31
    v_perm_b32 v245, v226, v222, s31
    v_perm_b32 v246, v234, v230, s31
    v_perm_b32 v247, v242, v238, s31
    s_waitcnt lgkmcnt(15)
    v_mfma_f32_32x32x16_bf16 v[128:143], v[180:183], v[100:103], v[128:143]
    v_add_f32 v8, v8, v208
    v_add_f32 v9, v9, v209
    v_cvt_pk_bf16_f32 v164, v208, v209
    v_mfma_f32_16x16x32_bf16 v[248:251], v[252:255], v[244:247], 0
    s_waitcnt lgkmcnt(13)
    v_mfma_f32_32x32x16_bf16 v[32:47], v[196:199], v[172:175], v[32:47]
    v_exp_f32 v210, v122
    v_exp_f32 v211, v123
    ds_read_b128 v[180:183], v4 offset:33920
    ds_read_b64_tr_b16 v[196:197], v5 offset:57600
    ds_read_b64_tr_b16 v[198:199], v5 offset:59648
    s_nop 0
    ds_write_b32 v14, v248 offset:16
    v_perm_b32 v244, v218, v214, s32
    v_perm_b32 v245, v226, v222, s32
    v_perm_b32 v246, v234, v230, s32
    v_perm_b32 v247, v242, v238, s32
    s_waitcnt lgkmcnt(15)
    v_mfma_f32_32x32x16_bf16 v[128:143], v[184:187], v[104:107], v[128:143]
    v_add_f32 v8, v8, v210
    v_add_f32 v9, v9, v211
    v_cvt_pk_bf16_f32 v165, v210, v211
    v_mfma_f32_16x16x32_bf16 v[248:251], v[252:255], v[244:247], 0
    s_waitcnt lgkmcnt(13)
    v_mfma_f32_32x32x16_bf16 v[48:63], v[200:203], v[172:175], v[48:63]
    v_exp_f32 v208, v124
    v_exp_f32 v209, v125
    ds_read_b128 v[184:187], v4 offset:34048
    ds_read_b64_tr_b16 v[200:201], v5 offset:57856
    ds_read_b64_tr_b16 v[202:203], v5 offset:59904
    s_nop 0
    ds_write_b32 v14, v248 offset:20
    v_perm_b32 v244, v219, v215, s31
    v_perm_b32 v245, v227, v223, s31
    v_perm_b32 v246, v235, v231, s31
    v_perm_b32 v247, v243, v239, s31
    s_waitcnt lgkmcnt(15)
    v_mfma_f32_32x32x16_bf16 v[128:143], v[188:191], v[108:111], v[128:143]
    v_add_f32 v8, v8, v208
    v_add_f32 v9, v9, v209
    v_cvt_pk_bf16_f32 v166, v208, v209
    v_mfma_f32_16x16x32_bf16 v[248:251], v[252:255], v[244:247], 0
    s_waitcnt lgkmcnt(13)
    v_mfma_f32_32x32x16_bf16 v[64:79], v[204:207], v[172:175], v[64:79]
    v_exp_f32 v210, v126
    v_exp_f32 v211, v127
    ds_read_b128 v[188:191], v4 offset:34176
    ds_read_b64_tr_b16 v[204:205], v5 offset:58112
    ds_read_b64_tr_b16 v[206:207], v5 offset:60160
    s_nop 0
    ds_write_b32 v14, v248 offset:24
    v_perm_b32 v244, v219, v215, s32
    v_perm_b32 v245, v227, v223, s32
    v_perm_b32 v246, v235, v231, s32
    v_perm_b32 v247, v243, v239, s32
    s_waitcnt lgkmcnt(15)
    v_mfma_f32_32x32x16_bf16 v[112:127], v[176:179], v[80:83], v[144:159]
    v_add_f32 v8, v8, v210
    v_add_f32 v9, v9, v211
    v_cvt_pk_bf16_f32 v167, v210, v211
    v_mfma_f32_16x16x32_bf16 v[248:251], v[252:255], v[244:247], 0
    s_waitcnt lgkmcnt(13)
    v_mfma_f32_32x32x16_bf16 v[16:31], v[192:195], v[160:163], v[16:31]
    v_exp_f32 v208, v128
    v_exp_f32 v209, v129
    ds_read_b128 v[176:179], v4 offset:34304
    ds_read_b64_tr_b16 v[192:193], v5 offset:61440
    ds_read_b64_tr_b16 v[194:195], v5 offset:63488
    s_waitcnt lgkmcnt(14)
    v_mfma_f32_32x32x16_bf16 v[112:127], v[180:183], v[84:87], v[112:127]
    v_add_f32 v8, v8, v208
    v_add_f32 v9, v9, v209
    v_cvt_pk_bf16_f32 v168, v208, v209
    s_waitcnt lgkmcnt(12)
    v_mfma_f32_32x32x16_bf16 v[32:47], v[196:199], v[160:163], v[32:47]
    v_exp_f32 v210, v130
    v_exp_f32 v211, v131
    ds_read_b128 v[180:183], v4 offset:34432
    ds_read_b64_tr_b16 v[196:197], v5 offset:61696
    ds_read_b64_tr_b16 v[198:199], v5 offset:63744
    ds_write_b32 v14, v248 offset:28
    s_waitcnt lgkmcnt(14)
    v_mfma_f32_32x32x16_bf16 v[112:127], v[184:187], v[88:91], v[112:127]
    v_add_f32 v8, v8, v210
    v_add_f32 v9, v9, v211
    v_cvt_pk_bf16_f32 v169, v210, v211
    s_waitcnt lgkmcnt(12)
    v_mfma_f32_32x32x16_bf16 v[48:63], v[200:203], v[160:163], v[48:63]
    v_exp_f32 v208, v132
    v_exp_f32 v209, v133
    ds_read_b128 v[184:187], v4 offset:34560
    ds_read_b64_tr_b16 v[200:201], v5 offset:61952
    ds_read_b64_tr_b16 v[202:203], v5 offset:64000
    s_waitcnt lgkmcnt(13)
    v_mfma_f32_32x32x16_bf16 v[112:127], v[188:191], v[92:95], v[112:127]
    v_add_f32 v8, v8, v208
    v_add_f32 v9, v9, v209
    v_cvt_pk_bf16_f32 v170, v208, v209
    s_waitcnt lgkmcnt(11)
    v_mfma_f32_32x32x16_bf16 v[64:79], v[204:207], v[160:163], v[64:79]
    v_exp_f32 v210, v134
    v_exp_f32 v211, v135
    ds_read_b128 v[188:191], v4 offset:34688
    ds_read_b64_tr_b16 v[204:205], v5 offset:62208
    ds_read_b64_tr_b16 v[206:207], v5 offset:64256
    s_waitcnt lgkmcnt(12)
    v_mfma_f32_32x32x16_bf16 v[112:127], v[176:179], v[96:99], v[112:127]
    v_add_f32 v8, v8, v210
    v_add_f32 v9, v9, v211
    v_cvt_pk_bf16_f32 v171, v210, v211
    s_waitcnt lgkmcnt(10)
    v_mfma_f32_32x32x16_bf16 v[16:31], v[192:195], v[164:167], v[16:31]
    v_exp_f32 v208, v136
    v_exp_f32 v209, v137
    ds_read_b128 v[176:179], v4 offset:42496
    ds_read_b64_tr_b16 v[192:193], v6 offset:8704
    ds_read_b64_tr_b16 v[194:195], v6 offset:10752
    s_add_u32 m0, s30, 16384
    v_lshlrev_b32 v15, 4, v0
    buffer_load_dwordx4 v15, s[68:71], s72 offen lds
    s_add_u32 s72, s72, 8192
    s_waitcnt lgkmcnt(12)
    v_mfma_f32_32x32x16_bf16 v[112:127], v[180:183], v[100:103], v[112:127]
    v_add_f32 v8, v8, v208
    v_add_f32 v9, v9, v209
    v_cvt_pk_bf16_f32 v172, v208, v209
    s_waitcnt lgkmcnt(10)
    v_mfma_f32_32x32x16_bf16 v[32:47], v[196:199], v[164:167], v[32:47]
    v_exp_f32 v210, v138
    v_exp_f32 v211, v139
    ds_read_b128 v[180:183], v4 offset:42624
    ds_read_b64_tr_b16 v[196:197], v6 offset:8960
    ds_read_b64_tr_b16 v[198:199], v6 offset:11008
    s_waitcnt lgkmcnt(11)
    v_mfma_f32_32x32x16_bf16 v[112:127], v[184:187], v[104:107], v[112:127]
    v_add_f32 v8, v8, v210
    v_add_f32 v9, v9, v211
    v_cvt_pk_bf16_f32 v173, v210, v211
    s_waitcnt lgkmcnt(9)
    v_mfma_f32_32x32x16_bf16 v[48:63], v[200:203], v[164:167], v[48:63]
    v_exp_f32 v208, v140
    v_exp_f32 v209, v141
    ds_read_b128 v[184:187], v4 offset:42752
    ds_read_b64_tr_b16 v[200:201], v6 offset:9216
    ds_read_b64_tr_b16 v[202:203], v6 offset:11264
    s_waitcnt lgkmcnt(11)
    v_mfma_f32_32x32x16_bf16 v[112:127], v[188:191], v[108:111], v[112:127]
    v_add_f32 v8, v8, v208
    v_add_f32 v9, v9, v209
    v_cvt_pk_bf16_f32 v174, v208, v209
    s_waitcnt lgkmcnt(9)
    v_mfma_f32_32x32x16_bf16 v[64:79], v[204:207], v[164:167], v[64:79]
    v_exp_f32 v210, v142
    v_exp_f32 v211, v143
    ds_read_b128 v[188:191], v4 offset:42880
    ds_read_b64_tr_b16 v[204:205], v6 offset:9472
    ds_read_b64_tr_b16 v[206:207], v6 offset:11520
    s_waitcnt vmcnt(4)
    s_barrier
    s_waitcnt lgkmcnt(11)
    v_mfma_f32_32x32x16_bf16 v[128:143], v[176:179], v[80:83], v[144:159]
    v_add_f32 v8, v8, v210
    v_add_f32 v9, v9, v211
    v_cvt_pk_bf16_f32 v175, v210, v211
    s_waitcnt lgkmcnt(9)
    v_mfma_f32_32x32x16_bf16 v[16:31], v[192:195], v[168:171], v[16:31]
    v_exp_f32 v208, v112
    v_exp_f32 v209, v113
    ds_read_b128 v[176:179], v4 offset:43008
    ds_read_b64_tr_b16 v[192:193], v6 offset:12800
    ds_read_b64_tr_b16 v[194:195], v6 offset:14848
    s_waitcnt lgkmcnt(11)
    v_mfma_f32_32x32x16_bf16 v[128:143], v[180:183], v[84:87], v[128:143]
    v_add_f32 v8, v8, v208
    v_add_f32 v9, v9, v209
    v_cvt_pk_bf16_f32 v160, v208, v209
    s_waitcnt lgkmcnt(9)
    v_mfma_f32_32x32x16_bf16 v[32:47], v[196:199], v[168:171], v[32:47]
    v_exp_f32 v210, v114
    v_exp_f32 v211, v115
    ds_read_b128 v[180:183], v4 offset:43136
    ds_read_b64_tr_b16 v[196:197], v6 offset:13056
    ds_read_b64_tr_b16 v[198:199], v6 offset:15104
    s_cmp_lg_u32 s3, 0
    s_cbranch_scc1 K2_FSKIP
    s_cmp_ge_u32 s2, 224
    s_cbranch_scc1 K2_FSKIP
    v_lshlrev_b32 v14, 3, v1
    v_add_u32 v15, 159744, v14
    ds_read_b64 v[212:213], v15 offset:0
    ds_read_b64 v[214:215], v15 offset:512
    ds_read_b64 v[216:217], v15 offset:1024
    ds_read_b64 v[218:219], v15 offset:1536
    ds_read_b64 v[220:221], v15 offset:2048
    ds_read_b64 v[222:223], v15 offset:2560
    ds_read_b64 v[224:225], v15 offset:3072
    ds_read_b64 v[226:227], v15 offset:3584
    s_and_b32 s60, s2, 3
    s_mul_i32 s60, s60, 57344
    s_lshr_b32 s61, s2, 2
    s_lshl_b32 s61, s61, 10
    s_add_u32 s60, s60, s61
    s_add_u32 s60, s60, 4259840
    v_lshlrev_b32 v14, 1, v14
    v_add_u32 v14, s60, v14
    s_waitcnt lgkmcnt(0)
    v_add_f32 v212, v212, v214
    v_add_f32 v213, v213, v215
    v_add_f32 v212, v212, v216
    v_add_f32 v213, v213, v217
    v_add_f32 v212, v212, v218
    v_add_f32 v213, v213, v219
    v_add_f32 v212, v212, v220
    v_add_f32 v213, v213, v221
    v_add_f32 v212, v212, v222
    v_add_f32 v213, v213, v223
    v_add_f32 v212, v212, v224
    v_add_f32 v213, v213, v225
    v_add_f32 v212, v212, v226
    v_add_f32 v213, v213, v227
    v_mov_b32 v214, v213
    v_mov_b32 v213, s33
    v_mov_b32 v215, s33
    global_store_dwordx4 v14, v[212:215], s[18:19] sc1
K2_FSKIP:
    s_waitcnt lgkmcnt(11)
    v_mfma_f32_32x32x16_bf16 v[128:143], v[184:187], v[88:91], v[128:143]
    v_add_f32 v8, v8, v210
    v_add_f32 v9, v9, v211
    v_cvt_pk_bf16_f32 v161, v210, v211
    s_waitcnt lgkmcnt(9)
    v_mfma_f32_32x32x16_bf16 v[48:63], v[200:203], v[168:171], v[48:63]
    v_exp_f32 v208, v116
    v_exp_f32 v209, v117
    ds_read_b128 v[184:187], v4 offset:43264
    ds_read_b64_tr_b16 v[200:201], v6 offset:13312
    ds_read_b64_tr_b16 v[202:203], v6 offset:15360
    s_and_b32 s60, s2, 7
    s_lshr_b32 s61, s2, 3
    s_lshr_b32 s20, s60, 1
    s_lshl_b32 s20, s20, 2
    s_and_b32 s62, s61, 3
    s_add_u32 s20, s20, s62
    s_lshr_b32 s21, s61, 2
    s_and_b32 s28, s60, 1
    s_and_b32 s29, s3, 3
    s_lshr_b32 s30, s3, 2
    s_xor_b32 s30, s30, s28
    s_xor_b32 s30, s30, 1
    s_lshl_b32 s61, s28, 23
    s_add_u32 s61, s61, 8388608
    s_add_u32 s36, s18, s61
    s_addc_u32 s37, s19, 0
    s_mov_b32 s38, 0x800000
    s_mov_b32 s39, 0x20000
    s_lshl_b32 s61, s28, 22
    s_add_u32 s40, s10, s61
    s_addc_u32 s41, s11, 0
    s_mov_b32 s42, 0x400000
    s_mov_b32 s43, 0x20000
    s_lshl_b32 s24, s20, 3
    s_add_u32 s24, s24, s3
    s_lshl_b32 s24, s24, 10
    s_lshl_b32 s25, s21, 8
    s_lshl_b32 s61, s3, 14
    s_add_u32 s25, s25, s61
    s_lshl_b32 s68, s3, 11
    s_add_u32 s68, s68, 16384
    s_lshl_b32 s69, s3, 10
    s_add_u32 s69, s69, 32768
    s_waitcnt lgkmcnt(11)
    v_mfma_f32_32x32x16_bf16 v[128:143], v[188:191], v[92:95], v[128:143]
    v_add_f32 v8, v8, v208
    v_add_f32 v9, v9, v209
    v_cvt_pk_bf16_f32 v162, v208, v209
    s_waitcnt lgkmcnt(9)
    v_mfma_f32_32x32x16_bf16 v[64:79], v[204:207], v[168:171], v[64:79]
    v_exp_f32 v210, v118
    v_exp_f32 v211, v119
    ds_read_b128 v[188:191], v4 offset:43392
    ds_read_b64_tr_b16 v[204:205], v6 offset:13568
    ds_read_b64_tr_b16 v[206:207], v6 offset:15616
    s_and_b32 s31, s65, 15
    s_lshr_b32 s32, s65, 4
    s_cmp_lg_u32 s30, s28
    s_cbranch_scc1 M_PL_S
    s_lshl_b32 s60, s20, 1
    s_add_u32 s60, s60, s28
    s_lshl_b32 s61, s60, 17
    s_lshl_b32 s60, s21, 2
    s_add_u32 s60, s60, s29
    s_lshl_b32 s62, s60, 6
    s_add_u32 s62, s61, s62
    v_and_b32 v249, 15, v1
    v_lshrrev_b32 v250, 4, v1
    v_lshlrev_b32 v248, 11, v249
    v_lshl_add_u32 v248, v250, 4, v248
    v_add_u32 v248, s62, v248
    s_lshl_b32 s62, s60, 10
    s_add_u32 s62, s61, s62
    v_lshlrev_b32 v249, 4, v249
    v_lshl_add_u32 v249, v250, 8, v249
    v_add_u32 v249, s62, v249
    v_mov_b32 v250, v248
    s_branch M_PL_E
M_PL_S:
    s_mul_i32 s60, s31, 224
    s_mul_i32 s61, s29, 56
    s_add_u32 s60, s60, s61
    s_lshl_b32 s61, s60, 11
    s_lshl_b32 s62, s32, 7
    s_add_u32 s61, s61, s62
    v_lshrrev_b32 v249, 3, v1
    v_lshlrev_b32 v249, 11, v249
    v_and_b32 v250, 7, v1
    v_lshl_add_u32 v249, v250, 4, v249
    v_add_u32 v249, s61, v249
    v_mov_b32 v248, 0
M_PL_E:
    s_waitcnt lgkmcnt(11)
    v_mfma_f32_32x32x16_bf16 v[128:143], v[176:179], v[96:99], v[128:143]
    v_add_f32 v8, v8, v210
    v_add_f32 v9, v9, v211
    v_cvt_pk_bf16_f32 v163, v210, v211
    s_waitcnt lgkmcnt(9)
    v_mfma_f32_32x32x16_bf16 v[16:31], v[192:195], v[172:175], v[16:31]
    v_exp_f32 v208, v120
    v_exp_f32 v209, v121
    ds_read_b128 v[176:179], v11 offset:0
    ds_read_b64_tr_b16 v[192:193], v6 offset:16896
    ds_read_b64_tr_b16 v[194:195], v6 offset:18944
    s_cmp_lg_u32 s30, s28
    s_cbranch_scc1 M_PLS1
    global_load_dwordx4 v[228:231], v249, s[18:19] sc1
    v_add_u32 v249, 0x8000, v249
    s_branch M_PLE1
M_PLS1:
    global_load_dwordx4 v[212:215], v249, s[16:17]
    v_add_u32 v249, 0x4000, v249
M_PLE1:
    s_waitcnt lgkmcnt(11)
    v_mfma_f32_32x32x16_bf16 v[128:143], v[180:183], v[100:103], v[128:143]
    v_add_f32 v8, v8, v208
    v_add_f32 v9, v9, v209
    v_cvt_pk_bf16_f32 v164, v208, v209
    s_waitcnt lgkmcnt(9)
    v_mfma_f32_32x32x16_bf16 v[32:47], v[196:199], v[172:175], v[32:47]
    v_exp_f32 v210, v122
    v_exp_f32 v211, v123
    ds_read_b128 v[180:183], v11 offset:128
    ds_read_b64_tr_b16 v[196:197], v6 offset:17152
    ds_read_b64_tr_b16 v[198:199], v6 offset:19200
    s_waitcnt lgkmcnt(11)
    v_mfma_f32_32x32x16_bf16 v[128:143], v[184:187], v[104:107], v[128:143]
    v_add_f32 v8, v8, v210
    v_add_f32 v9, v9, v211
    v_cvt_pk_bf16_f32 v165, v210, v211
    s_waitcnt lgkmcnt(9)
    v_mfma_f32_32x32x16_bf16 v[48:63], v[200:203], v[172:175], v[48:63]
    v_exp_f32 v208, v124
    v_exp_f32 v209, v125
    ds_read_b128 v[184:187], v11 offset:256
    ds_read_b64_tr_b16 v[200:201], v6 offset:17408
    ds_read_b64_tr_b16 v[202:203], v6 offset:19456
    s_cmp_lg_u32 s30, s28
    s_cbranch_scc1 M_PLS2
    global_load_dwordx4 v[232:235], v249, s[18:19] sc1
    v_add_u32 v249, 0x8000, v249
    s_branch M_PLE2
M_PLS2:
    global_load_dwordx4 v[216:219], v249, s[16:17]
    v_add_u32 v249, 0x4000, v249
M_PLE2:
    s_waitcnt lgkmcnt(11)
    v_mfma_f32_32x32x16_bf16 v[128:143], v[188:191], v[108:111], v[128:143]
    v_add_f32 v8, v8, v208
    v_add_f32 v9, v9, v209
    v_cvt_pk_bf16_f32 v166, v208, v209
    s_waitcnt lgkmcnt(9)
    v_mfma_f32_32x32x16_bf16 v[64:79], v[204:207], v[172:175], v[64:79]
    v_exp_f32 v210, v126
    v_exp_f32 v211, v127
    ds_read_b128 v[188:191], v11 offset:384
    ds_read_b64_tr_b16 v[204:205], v6 offset:17664
    ds_read_b64_tr_b16 v[206:207], v6 offset:19712
    s_waitcnt lgkmcnt(11)
    v_mfma_f32_32x32x16_bf16 v[112:127], v[176:179], v[80:83], v[144:159]
    v_add_f32 v8, v8, v210
    v_add_f32 v9, v9, v211
    v_cvt_pk_bf16_f32 v167, v210, v211
    s_waitcnt lgkmcnt(9)
    v_mfma_f32_32x32x16_bf16 v[16:31], v[192:195], v[160:163], v[16:31]
    v_exp_f32 v208, v128
    v_exp_f32 v209, v129
    ds_read_b128 v[176:179], v11 offset:512
    ds_read_b64_tr_b16 v[192:193], v6 offset:20992
    ds_read_b64_tr_b16 v[194:195], v6 offset:23040
    s_cmp_lg_u32 s30, s28
    s_cbranch_scc1 M_PLS3
    global_load_dwordx4 v[236:239], v249, s[18:19] sc1
    v_add_u32 v249, 0x8000, v249
    s_branch M_PLE3
M_PLS3:
    global_load_dwordx4 v[220:223], v249, s[16:17]
    v_add_u32 v249, 0x4000, v249
M_PLE3:
    s_waitcnt lgkmcnt(11)
    v_mfma_f32_32x32x16_bf16 v[112:127], v[180:183], v[84:87], v[112:127]
    v_add_f32 v8, v8, v208
    v_add_f32 v9, v9, v209
    v_cvt_pk_bf16_f32 v168, v208, v209
    s_waitcnt lgkmcnt(9)
    v_mfma_f32_32x32x16_bf16 v[32:47], v[196:199], v[160:163], v[32:47]
    v_exp_f32 v210, v130
    v_exp_f32 v211, v131
    ds_read_b128 v[180:183], v11 offset:640
    ds_read_b64_tr_b16 v[196:197], v6 offset:21248
    ds_read_b64_tr_b16 v[198:199], v6 offset:23296
    s_waitcnt lgkmcnt(11)
    v_mfma_f32_32x32x16_bf16 v[112:127], v[184:187], v[88:91], v[112:127]
    v_add_f32 v8, v8, v210
    v_add_f32 v9, v9, v211
    v_cvt_pk_bf16_f32 v169, v210, v211
    s_waitcnt lgkmcnt(9)
    v_mfma_f32_32x32x16_bf16 v[48:63], v[200:203], v[160:163], v[48:63]
    v_exp_f32 v208, v132
    v_exp_f32 v209, v133
    ds_read_b128 v[184:187], v11 offset:768
    ds_read_b64_tr_b16 v[200:201], v6 offset:21504
    ds_read_b64_tr_b16 v[202:203], v6 offset:23552
    s_cmp_lg_u32 s30, s28
    s_cbranch_scc1 M_PLS4
    global_load_dwordx4 v[240:243], v249, s[18:19] sc1
    v_add_u32 v249, 0x8000, v249
    s_branch M_PLE4
M_PLS4:
    global_load_dwordx4 v[224:227], v249, s[16:17]
    v_add_u32 v249, 0x4000, v249
M_PLE4:
    s_waitcnt lgkmcnt(11)
    v_mfma_f32_32x32x16_bf16 v[112:127], v[188:191], v[92:95], v[112:127]
    v_add_f32 v8, v8, v208
    v_add_f32 v9, v9, v209
    v_cvt_pk_bf16_f32 v170, v208, v209
    s_waitcnt lgkmcnt(9)
    v_mfma_f32_32x32x16_bf16 v[64:79], v[204:207], v[160:163], v[64:79]
    v_exp_f32 v210, v134
    v_exp_f32 v211, v135
    ds_read_b128 v[188:191], v11 offset:896
    ds_read_b64_tr_b16 v[204:205], v6 offset:21760
    ds_read_b64_tr_b16 v[206:207], v6 offset:23808
    s_cmp_lg_u32 s30, s28
    s_cbranch_scc1 M_PLS5
    global_load_dwordx4 v[212:215], v250, s[74:75]
    v_add_u32 v250, 0x8000, v250
    s_branch M_PLE5
M_PLS5:
    global_load_dwordx4 v[228:231], v249, s[16:17]
    v_add_u32 v249, 0x4000, v249
M_PLE5:
    s_waitcnt lgkmcnt(11)
    v_mfma_f32_32x32x16_bf16 v[112:127], v[176:179], v[96:99], v[112:127]
    v_add_f32 v8, v8, v210
    v_add_f32 v9, v9, v211
    v_cvt_pk_bf16_f32 v171, v210, v211
    s_waitcnt lgkmcnt(9)
    v_mfma_f32_32x32x16_bf16 v[16:31], v[192:195], v[164:167], v[16:31]
    v_exp_f32 v208, v136
    v_exp_f32 v209, v137
    ds_read_b128 v[176:179], v11 offset:8704
    ds_read_b64_tr_b16 v[192:193], v6 offset:51200
    ds_read_b64_tr_b16 v[194:195], v6 offset:53248
    s_waitcnt lgkmcnt(11)
    v_mfma_f32_32x32x16_bf16 v[112:127], v[180:183], v[100:103], v[112:127]
    v_add_f32 v8, v8, v208
    v_add_f32 v9, v9, v209
    v_cvt_pk_bf16_f32 v172, v208, v209
    s_waitcnt lgkmcnt(9)
    v_mfma_f32_32x32x16_bf16 v[32:47], v[196:199], v[164:167], v[32:47]
    v_exp_f32 v210, v138
    v_exp_f32 v211, v139
    ds_read_b128 v[180:183], v11 offset:8832
    ds_read_b64_tr_b16 v[196:197], v6 offset:51456
    ds_read_b64_tr_b16 v[198:199], v6 offset:53504
    s_cmp_lg_u32 s30, s28
    s_cbranch_scc1 M_PLS6
    global_load_dwordx4 v[216:219], v250, s[74:75]
    v_add_u32 v250, 0x8000, v250
    s_branch M_PLE6
M_PLS6:
    global_load_dwordx4 v[232:235], v249, s[16:17]
    v_add_u32 v249, 0x4000, v249
M_PLE6:
    s_waitcnt lgkmcnt(11)
    v_mfma_f32_32x32x16_bf16 v[112:127], v[184:187], v[104:107], v[112:127]
    v_add_f32 v8, v8, v210
    v_add_f32 v9, v9, v211
    v_cvt_pk_bf16_f32 v173, v210, v211
    s_waitcnt lgkmcnt(9)
    v_mfma_f32_32x32x16_bf16 v[48:63], v[200:203], v[164:167], v[48:63]
    v_exp_f32 v208, v140
    v_exp_f32 v209, v141
    ds_read_b128 v[184:187], v11 offset:8960
    ds_read_b64_tr_b16 v[200:201], v6 offset:51712
    ds_read_b64_tr_b16 v[202:203], v6 offset:53760
    s_cmp_lg_u32 s30, s28
    s_cbranch_scc1 M_PLS7
    global_load_dwordx4 v[220:223], v250, s[74:75]
    v_add_u32 v250, 0x8000, v250
    s_branch M_PLE7
M_PLS7:
    global_load_dwordx4 v[236:239], v249, s[16:17]
    v_add_u32 v249, 0x4000, v249
M_PLE7:
    s_waitcnt lgkmcnt(11)
    v_mfma_f32_32x32x16_bf16 v[112:127], v[188:191], v[108:111], v[112:127]
    v_add_f32 v8, v8, v208
    v_add_f32 v9, v9, v209
    v_cvt_pk_bf16_f32 v174, v208, v209
    s_waitcnt lgkmcnt(9)
    v_mfma_f32_32x32x16_bf16 v[64:79], v[204:207], v[164:167], v[64:79]
    v_exp_f32 v210, v142
    v_exp_f32 v211, v143
    ds_read_b128 v[188:191], v11 offset:9088
    ds_read_b64_tr_b16 v[204:205], v6 offset:51968
    ds_read_b64_tr_b16 v[206:207], v6 offset:54016
    s_cmp_lg_u32 s30, s28
    s_cbranch_scc1 M_PLS8
    global_load_dwordx4 v[224:227], v250, s[74:75]
    v_add_u32 v250, 0x8000, v250
    s_branch M_PLE8
M_PLS8:
M_PLE8:
    s_waitcnt vmcnt(7)
    s_barrier
    s_setprio 2
    s_waitcnt lgkmcnt(11)
    v_mfma_f32_32x32x16_bf16 v[128:143], v[176:179], v[80:83], v[144:159]
    v_add_f32 v8, v8, v210
    v_add_f32 v9, v9, v211
    v_cvt_pk_bf16_f32 v175, v210, v211
    s_waitcnt lgkmcnt(9)
    v_mfma_f32_32x32x16_bf16 v[16:31], v[192:195], v[168:171], v[16:31]
    v_exp_f32 v208, v112
    v_exp_f32 v209, v113
    ds_read_b128 v[176:179], v11 offset:9216
    ds_read_b64_tr_b16 v[192:193], v6 offset:55296
    ds_read_b64_tr_b16 v[194:195], v6 offset:57344
    s_waitcnt lgkmcnt(11)
    v_mfma_f32_32x32x16_bf16 v[128:143], v[180:183], v[84:87], v[128:143]
    v_add_f32 v8, v8, v208
    v_add_f32 v9, v9, v209
    v_cvt_pk_bf16_f32 v160, v208, v209
    s_waitcnt lgkmcnt(9)
    v_mfma_f32_32x32x16_bf16 v[32:47], v[196:199], v[168:171], v[32:47]
    v_exp_f32 v210, v114
    v_exp_f32 v211, v115
    ds_read_b128 v[180:183], v11 offset:9344
    ds_read_b64_tr_b16 v[196:197], v6 offset:55552
    ds_read_b64_tr_b16 v[198:199], v6 offset:57600
    s_waitcnt lgkmcnt(11)
    v_mfma_f32_32x32x16_bf16 v[128:143], v[184:187], v[88:91], v[128:143]
    v_add_f32 v8, v8, v210
    v_add_f32 v9, v9, v211
    v_cvt_pk_bf16_f32 v161, v210, v211
    s_waitcnt lgkmcnt(9)
    v_mfma_f32_32x32x16_bf16 v[48:63], v[200:203], v[168:171], v[48:63]
    v_exp_f32 v208, v116
    v_exp_f32 v209, v117
    ds_read_b128 v[184:187], v11 offset:9472
    ds_read_b64_tr_b16 v[200:201], v6 offset:55808
    ds_read_b64_tr_b16 v[202:203], v6 offset:57856
    s_waitcnt lgkmcnt(11)
    v_mfma_f32_32x32x16_bf16 v[128:143], v[188:191], v[92:95], v[128:143]
    v_add_f32 v8, v8, v208
    v_add_f32 v9, v9, v209
    v_cvt_pk_bf16_f32 v162, v208, v209
    s_waitcnt lgkmcnt(9)
    v_mfma_f32_32x32x16_bf16 v[64:79], v[204:207], v[168:171], v[64:79]
    v_exp_f32 v210, v118
    v_exp_f32 v211, v119
    ds_read_b128 v[188:191], v11 offset:9600
    ds_read_b64_tr_b16 v[204:205], v6 offset:56064
    ds_read_b64_tr_b16 v[206:207], v6 offset:58112
    s_waitcnt lgkmcnt(11)
    v_mfma_f32_32x32x16_bf16 v[128:143], v[176:179], v[96:99], v[128:143]
    v_add_f32 v8, v8, v210
    v_add_f32 v9, v9, v211
    v_cvt_pk_bf16_f32 v163, v210, v211
    s_waitcnt lgkmcnt(9)
    v_mfma_f32_32x32x16_bf16 v[16:31], v[192:195], v[172:175], v[16:31]
    v_exp_f32 v208, v120
    v_exp_f32 v209, v121
    ds_read_b64_tr_b16 v[192:193], v5 offset:0
    ds_read_b64_tr_b16 v[194:195], v5 offset:2048
    s_waitcnt lgkmcnt(10)
    v_mfma_f32_32x32x16_bf16 v[128:143], v[180:183], v[100:103], v[128:143]
    v_add_f32 v8, v8, v208
    v_add_f32 v9, v9, v209
    v_cvt_pk_bf16_f32 v164, v208, v209
    s_waitcnt lgkmcnt(8)
    v_mfma_f32_32x32x16_bf16 v[32:47], v[196:199], v[172:175], v[32:47]
    v_exp_f32 v210, v122
    v_exp_f32 v211, v123
    ds_read_b64_tr_b16 v[196:197], v5 offset:256
    ds_read_b64_tr_b16 v[198:199], v5 offset:2304
    s_waitcnt lgkmcnt(9)
    v_mfma_f32_32x32x16_bf16 v[128:143], v[184:187], v[104:107], v[128:143]
    v_add_f32 v8, v8, v210
    v_add_f32 v9, v9, v211
    v_cvt_pk_bf16_f32 v165, v210, v211
    s_waitcnt lgkmcnt(7)
    v_mfma_f32_32x32x16_bf16 v[48:63], v[200:203], v[172:175], v[48:63]
    v_exp_f32 v208, v124
    v_exp_f32 v209, v125
    ds_read_b64_tr_b16 v[200:201], v5 offset:512
    ds_read_b64_tr_b16 v[202:203], v5 offset:2560
    s_waitcnt lgkmcnt(8)
    v_mfma_f32_32x32x16_bf16 v[128:143], v[188:191], v[108:111], v[128:143]
    v_add_f32 v8, v8, v208
    v_add_f32 v9, v9, v209
    v_cvt_pk_bf16_f32 v166, v208, v209
    s_waitcnt lgkmcnt(6)
    v_mfma_f32_32x32x16_bf16 v[64:79], v[204:207], v[172:175], v[64:79]
    v_exp_f32 v210, v126
    v_exp_f32 v211, v127
    ds_read_b64_tr_b16 v[204:205], v5 offset:768
    ds_read_b64_tr_b16 v[206:207], v5 offset:2816
    v_add_f32 v8, v8, v210
    v_add_f32 v9, v9, v211
    v_cvt_pk_bf16_f32 v167, v210, v211
    s_waitcnt lgkmcnt(6)
    v_mfma_f32_32x32x16_bf16 v[16:31], v[192:195], v[160:163], v[16:31]
    v_exp_f32 v208, v128
    v_exp_f32 v209, v129
    ds_read_b64_tr_b16 v[192:193], v5 offset:4096
    ds_read_b64_tr_b16 v[194:195], v5 offset:6144
    v_add_f32 v8, v8, v208
    v_add_f32 v9, v9, v209
    v_cvt_pk_bf16_f32 v168, v208, v209
    s_waitcnt lgkmcnt(6)
    v_mfma_f32_32x32x16_bf16 v[32:47], v[196:199], v[160:163], v[32:47]
    v_exp_f32 v210, v130
    v_exp_f32 v211, v131
    ds_read_b64_tr_b16 v[196:197], v5 offset:4352
    ds_read_b64_tr_b16 v[198:199], v5 offset:6400
    v_add_f32 v8, v8, v210
    v_add_f32 v9, v9, v211
    v_cvt_pk_bf16_f32 v169, v210, v211
    s_waitcnt lgkmcnt(6)
    v_mfma_f32_32x32x16_bf16 v[48:63], v[200:203], v[160:163], v[48:63]
    v_exp_f32 v208, v132
    v_exp_f32 v209, v133
    ds_read_b64_tr_b16 v[200:201], v5 offset:4608
    ds_read_b64_tr_b16 v[202:203], v5 offset:6656
    v_add_f32 v8, v8, v208
    v_add_f32 v9, v9, v209
    v_cvt_pk_bf16_f32 v170, v208, v209
    s_waitcnt lgkmcnt(6)
    v_mfma_f32_32x32x16_bf16 v[64:79], v[204:207], v[160:163], v[64:79]
    v_exp_f32 v210, v134
    v_exp_f32 v211, v135
    ds_read_b64_tr_b16 v[204:205], v5 offset:4864
    ds_read_b64_tr_b16 v[206:207], v5 offset:6912
    v_add_f32 v8, v8, v210
    v_add_f32 v9, v9, v211
    v_cvt_pk_bf16_f32 v171, v210, v211
    s_waitcnt lgkmcnt(6)
    v_mfma_f32_32x32x16_bf16 v[16:31], v[192:195], v[164:167], v[16:31]
    v_exp_f32 v208, v136
    v_exp_f32 v209, v137
    ds_read_b64_tr_b16 v[192:193], v5 offset:8192
    ds_read_b64_tr_b16 v[194:195], v5 offset:10240
    v_add_f32 v8, v8, v208
    v_add_f32 v9, v9, v209
    v_cvt_pk_bf16_f32 v172, v208, v209
    s_waitcnt lgkmcnt(6)
    v_mfma_f32_32x32x16_bf16 v[32:47], v[196:199], v[164:167], v[32:47]
    v_exp_f32 v210, v138
    v_exp_f32 v211, v139
    ds_read_b64_tr_b16 v[196:197], v5 offset:8448
    ds_read_b64_tr_b16 v[198:199], v5 offset:10496
    v_add_f32 v8, v8, v210
    v_add_f32 v9, v9, v211
    v_cvt_pk_bf16_f32 v173, v210, v211
    s_waitcnt lgkmcnt(6)
    v_mfma_f32_32x32x16_bf16 v[48:63], v[200:203], v[164:167], v[48:63]
    v_exp_f32 v208, v140
    v_exp_f32 v209, v141
    ds_read_b64_tr_b16 v[200:201], v5 offset:8704
    ds_read_b64_tr_b16 v[202:203], v5 offset:10752
    v_add_f32 v8, v8, v208
    v_add_f32 v9, v9, v209
    v_cvt_pk_bf16_f32 v174, v208, v209
    s_waitcnt lgkmcnt(6)
    v_mfma_f32_32x32x16_bf16 v[64:79], v[204:207], v[164:167], v[64:79]
    v_exp_f32 v210, v142
    v_exp_f32 v211, v143
    ds_read_b64_tr_b16 v[204:205], v5 offset:8960
    ds_read_b64_tr_b16 v[206:207], v5 offset:11008
    v_add_f32 v8, v8, v210
    v_add_f32 v9, v9, v211
    v_cvt_pk_bf16_f32 v175, v210, v211
    v_add_f32 v8, v8, v9
    v_mov_b32 v9, v8
    s_waitcnt lgkmcnt(6)
    v_mfma_f32_32x32x16_bf16 v[16:31], v[192:195], v[168:171], v[16:31]
    ds_read_b64_tr_b16 v[192:193], v5 offset:12288
    ds_read_b64_tr_b16 v[194:195], v5 offset:14336
    v_permlane32_swap_b32 v8, v9
    v_add_f32 v8, v8, v9
    s_waitcnt lgkmcnt(6)
    v_mfma_f32_32x32x16_bf16 v[32:47], v[196:199], v[168:171], v[32:47]
    ds_read_b64_tr_b16 v[196:197], v5 offset:12544
    ds_read_b64_tr_b16 v[198:199], v5 offset:14592
    v_mov_b32 v13, 0x5d800000
    v_cmp_nle_f32 vcc, v8, v13
    v_rcp_f32 v9, v8
    s_waitcnt lgkmcnt(6)
    v_mfma_f32_32x32x16_bf16 v[48:63], v[200:203], v[168:171], v[48:63]
    ds_read_b64_tr_b16 v[200:201], v5 offset:12800
    ds_read_b64_tr_b16 v[202:203], v5 offset:14848
    s_waitcnt lgkmcnt(6)
    v_mfma_f32_32x32x16_bf16 v[64:79], v[204:207], v[168:171], v[64:79]
    ds_read_b64_tr_b16 v[204:205], v5 offset:13056
    ds_read_b64_tr_b16 v[206:207], v5 offset:15104
    s_waitcnt lgkmcnt(6)
    v_mfma_f32_32x32x16_bf16 v[16:31], v[192:195], v[172:175], v[16:31]
    s_waitcnt lgkmcnt(4)
    v_mfma_f32_32x32x16_bf16 v[32:47], v[196:199], v[172:175], v[32:47]
    s_waitcnt lgkmcnt(2)
    v_mfma_f32_32x32x16_bf16 v[48:63], v[200:203], v[172:175], v[48:63]
    s_waitcnt lgkmcnt(0)
    v_mfma_f32_32x32x16_bf16 v[64:79], v[204:207], v[172:175], v[64:79]
    s_cbranch_vccnz K2_SLOW
K2_SLOW_RET:
    s_nop 4
    v_mul_f32 v16, v16, v9
    v_mul_f32 v17, v17, v9
    v_mul_f32 v18, v18, v9
    v_mul_f32 v19, v19, v9
    v_mul_f32 v20, v20, v9
    v_mul_f32 v21, v21, v9
    v_mul_f32 v22, v22, v9
    v_mul_f32 v23, v23, v9
    v_cvt_pk_bf16_f32 v112, v16, v17
    v_cvt_pk_bf16_f32 v113, v18, v19
    v_cvt_pk_bf16_f32 v114, v20, v21
    v_cvt_pk_bf16_f32 v115, v22, v23
    buffer_store_dwordx4 v[112:115], v7, s[56:59], s64 offen offset:0 sc1
    v_mul_f32 v24, v24, v9
    v_mul_f32 v25, v25, v9
    v_mul_f32 v26, v26, v9
    v_mul_f32 v27, v27, v9
    v_mul_f32 v28, v28, v9
    v_mul_f32 v29, v29, v9
    v_mul_f32 v30, v30, v9
    v_mul_f32 v31, v31, v9
    v_cvt_pk_bf16_f32 v116, v24, v25
    v_cvt_pk_bf16_f32 v117, v26, v27
    v_cvt_pk_bf16_f32 v118, v28, v29
    v_cvt_pk_bf16_f32 v119, v30, v31
    buffer_store_dwordx4 v[116:119], v7, s[56:59], s64 offen offset:512 sc1
    s_add_u32 s64, s64, 131072
    v_mul_f32 v32, v32, v9
    v_mul_f32 v33, v33, v9
    v_mul_f32 v34, v34, v9
    v_mul_f32 v35, v35, v9
    v_mul_f32 v36, v36, v9
    v_mul_f32 v37, v37, v9
    v_mul_f32 v38, v38, v9
    v_mul_f32 v39, v39, v9
    v_cvt_pk_bf16_f32 v120, v32, v33
    v_cvt_pk_bf16_f32 v121, v34, v35
    v_cvt_pk_bf16_f32 v122, v36, v37
    v_cvt_pk_bf16_f32 v123, v38, v39
    buffer_store_dwordx4 v[120:123], v7, s[56:59], s64 offen offset:0 sc1
    v_mul_f32 v40, v40, v9
    v_mul_f32 v41, v41, v9
    v_mul_f32 v42, v42, v9
    v_mul_f32 v43, v43, v9
    v_mul_f32 v44, v44, v9
    v_mul_f32 v45, v45, v9
    v_mul_f32 v46, v46, v9
    v_mul_f32 v47, v47, v9
    v_cvt_pk_bf16_f32 v124, v40, v41
    v_cvt_pk_bf16_f32 v125, v42, v43
    v_cvt_pk_bf16_f32 v126, v44, v45
    v_cvt_pk_bf16_f32 v127, v46, v47
    buffer_store_dwordx4 v[124:127], v7, s[56:59], s64 offen offset:512 sc1
    s_add_u32 s64, s64, 131072
    v_mul_f32 v48, v48, v9
    v_mul_f32 v49, v49, v9
    v_mul_f32 v50, v50, v9
    v_mul_f32 v51, v51, v9
    v_mul_f32 v52, v52, v9
    v_mul_f32 v53, v53, v9
    v_mul_f32 v54, v54, v9
    v_mul_f32 v55, v55, v9
    v_cvt_pk_bf16_f32 v128, v48, v49
    v_cvt_pk_bf16_f32 v129, v50, v51
    v_cvt_pk_bf16_f32 v130, v52, v53
    v_cvt_pk_bf16_f32 v131, v54, v55
    buffer_store_dwordx4 v[128:131], v7, s[56:59], s64 offen offset:0 sc1
    v_mul_f32 v56, v56, v9
    v_mul_f32 v57, v57, v9
    v_mul_f32 v58, v58, v9
    v_mul_f32 v59, v59, v9
    v_mul_f32 v60, v60, v9
    v_mul_f32 v61, v61, v9
    v_mul_f32 v62, v62, v9
    v_mul_f32 v63, v63, v9
    v_cvt_pk_bf16_f32 v132, v56, v57
    v_cvt_pk_bf16_f32 v133, v58, v59
    v_cvt_pk_bf16_f32 v134, v60, v61
    v_cvt_pk_bf16_f32 v135, v62, v63
    buffer_store_dwordx4 v[132:135], v7, s[56:59], s64 offen offset:512 sc1
    s_add_u32 s64, s64, 131072
    v_mul_f32 v64, v64, v9
    v_mul_f32 v65, v65, v9
    v_mul_f32 v66, v66, v9
    v_mul_f32 v67, v67, v9
    v_mul_f32 v68, v68, v9
    v_mul_f32 v69, v69, v9
    v_mul_f32 v70, v70, v9
    v_mul_f32 v71, v71, v9
    v_cvt_pk_bf16_f32 v136, v64, v65
    v_cvt_pk_bf16_f32 v137, v66, v67
    v_cvt_pk_bf16_f32 v138, v68, v69
    v_cvt_pk_bf16_f32 v139, v70, v71
    buffer_store_dwordx4 v[136:139], v7, s[56:59], s64 offen offset:0 sc1
    v_mul_f32 v72, v72, v9
    v_mul_f32 v73, v73, v9
    v_mul_f32 v74, v74, v9
    v_mul_f32 v75, v75, v9
    v_mul_f32 v76, v76, v9
    v_mul_f32 v77, v77, v9
    v_mul_f32 v78, v78, v9
    v_mul_f32 v79, v79, v9
    v_cvt_pk_bf16_f32 v140, v72, v73
    v_cvt_pk_bf16_f32 v141, v74, v75
    v_cvt_pk_bf16_f32 v142, v76, v77
    v_cvt_pk_bf16_f32 v143, v78, v79
    buffer_store_dwordx4 v[140:143], v7, s[56:59], s64 offen offset:512 sc1
    s_setprio 0
    v_lshrrev_b32 v12, 4, v1
    v_and_b32 v13, 3, v1
    v_bfe_u32 v15, v1, 2, 2
    v_lshlrev_b32 v4, 4, v13
    v_lshl_add_u32 v4, v12, 6, v4
    v_lshl_add_u32 v4, v15, 11, v4
    v_add_u32 v5, 7168, v4
    v_mov_b32 v9, v248
    s_waitcnt vmcnt(8)
    s_cmp_lg_u32 s30, s28
    s_cbranch_scc1 M_SEND0
    v_lshlrev_b32 v144, 16, v228
    v_and_b32 v145, 0xffff0000, v228
    v_lshlrev_b32 v146, 16, v229
    v_and_b32 v147, 0xffff0000, v229
    v_lshlrev_b32 v148, 16, v230
    v_and_b32 v149, 0xffff0000, v230
    v_lshlrev_b32 v150, 16, v231
    v_and_b32 v151, 0xffff0000, v231
    v_lshlrev_b32 v152, 16, v232
    v_and_b32 v153, 0xffff0000, v232
    v_lshlrev_b32 v154, 16, v233
    v_and_b32 v155, 0xffff0000, v233
    v_lshlrev_b32 v156, 16, v234
    v_and_b32 v157, 0xffff0000, v234
    v_lshlrev_b32 v158, 16, v235
    v_and_b32 v159, 0xffff0000, v235
    v_lshlrev_b32 v160, 16, v236
    v_and_b32 v161, 0xffff0000, v236
    v_lshlrev_b32 v162, 16, v237
    v_and_b32 v163, 0xffff0000, v237
    v_lshlrev_b32 v164, 16, v238
    v_and_b32 v165, 0xffff0000, v238
    v_lshlrev_b32 v166, 16, v239
    v_and_b32 v167, 0xffff0000, v239
    v_lshlrev_b32 v168, 16, v240
    v_and_b32 v169, 0xffff0000, v240
    v_lshlrev_b32 v170, 16, v241
    v_and_b32 v171, 0xffff0000, v241
    v_lshlrev_b32 v172, 16, v242
    v_and_b32 v173, 0xffff0000, v242
    v_lshlrev_b32 v174, 16, v243
    v_and_b32 v175, 0xffff0000, v243
    v_mul_f32 v176, 0xbfb8aa3b, v144
    v_mul_f32 v177, 0xbfb8aa3b, v145
    v_mul_f32 v178, 0xbfb8aa3b, v146
    v_mul_f32 v179, 0xbfb8aa3b, v147
    v_mul_f32 v180, 0xbfb8aa3b, v148
    v_mul_f32 v181, 0xbfb8aa3b, v149
    v_mul_f32 v182, 0xbfb8aa3b, v150
    v_mul_f32 v183, 0xbfb8aa3b, v151
    v_mul_f32 v184, 0xbfb8aa3b, v152
    v_mul_f32 v185, 0xbfb8aa3b, v153
    v_mul_f32 v186, 0xbfb8aa3b, v154
    v_mul_f32 v187, 0xbfb8aa3b, v155
    v_mul_f32 v188, 0xbfb8aa3b, v156
    v_mul_f32 v189, 0xbfb8aa3b, v157
    v_mul_f32 v190, 0xbfb8aa3b, v158
    v_mul_f32 v191, 0xbfb8aa3b, v159
    v_mul_f32 v192, 0xbfb8aa3b, v160
    v_mul_f32 v193, 0xbfb8aa3b, v161
    v_mul_f32 v194, 0xbfb8aa3b, v162
    v_mul_f32 v195, 0xbfb8aa3b, v163
    v_mul_f32 v196, 0xbfb8aa3b, v164
    v_mul_f32 v197, 0xbfb8aa3b, v165
    v_mul_f32 v198, 0xbfb8aa3b, v166
    v_mul_f32 v199, 0xbfb8aa3b, v167
    v_mul_f32 v200, 0xbfb8aa3b, v168
    v_mul_f32 v201, 0xbfb8aa3b, v169
    v_mul_f32 v202, 0xbfb8aa3b, v170
    v_mul_f32 v203, 0xbfb8aa3b, v171
    v_mul_f32 v204, 0xbfb8aa3b, v172
    v_mul_f32 v205, 0xbfb8aa3b, v173
    v_mul_f32 v206, 0xbfb8aa3b, v174
    v_mul_f32 v207, 0xbfb8aa3b, v175
    v_exp_f32 v176, v176
    v_exp_f32 v177, v177
    v_exp_f32 v178, v178
    v_exp_f32 v179, v179
    v_exp_f32 v180, v180
    v_exp_f32 v181, v181
    v_exp_f32 v182, v182
    v_exp_f32 v183, v183
    v_exp_f32 v184, v184
    v_exp_f32 v185, v185
    v_exp_f32 v186, v186
    v_exp_f32 v187, v187
    v_exp_f32 v188, v188
    v_exp_f32 v189, v189
    v_exp_f32 v190, v190
    v_exp_f32 v191, v191
    v_exp_f32 v192, v192
    v_exp_f32 v193, v193
    v_exp_f32 v194, v194
    v_exp_f32 v195, v195
    v_exp_f32 v196, v196
    v_exp_f32 v197, v197
    v_exp_f32 v198, v198
    v_exp_f32 v199, v199
    v_exp_f32 v200, v200
    v_exp_f32 v201, v201
    v_exp_f32 v202, v202
    v_exp_f32 v203, v203
    v_exp_f32 v204, v204
    v_exp_f32 v205, v205
    v_exp_f32 v206, v206
    v_exp_f32 v207, v207
    v_add_f32 v176, 1.0, v176
    v_add_f32 v177, 1.0, v177
    v_add_f32 v178, 1.0, v178
    v_add_f32 v179, 1.0, v179
    v_add_f32 v180, 1.0, v180
    v_add_f32 v181, 1.0, v181
    v_add_f32 v182, 1.0, v182
    v_add_f32 v183, 1.0, v183
    v_add_f32 v184, 1.0, v184
    v_add_f32 v185, 1.0, v185
    v_add_f32 v186, 1.0, v186
    v_add_f32 v187, 1.0, v187
    v_add_f32 v188, 1.0, v188
    v_add_f32 v189, 1.0, v189
    v_add_f32 v190, 1.0, v190
    v_add_f32 v191, 1.0, v191
    v_add_f32 v192, 1.0, v192
    v_add_f32 v193, 1.0, v193
    v_add_f32 v194, 1.0, v194
    v_add_f32 v195, 1.0, v195
    v_add_f32 v196, 1.0, v196
    v_add_f32 v197, 1.0, v197
    v_add_f32 v198, 1.0, v198
    v_add_f32 v199, 1.0, v199
    v_add_f32 v200, 1.0, v200
    v_add_f32 v201, 1.0, v201
    v_add_f32 v202, 1.0, v202
    v_add_f32 v203, 1.0, v203
    v_add_f32 v204, 1.0, v204
    v_add_f32 v205, 1.0, v205
    v_add_f32 v206, 1.0, v206
    v_add_f32 v207, 1.0, v207
    v_rcp_f32 v176, v176
    v_rcp_f32 v177, v177
    v_rcp_f32 v178, v178
    v_rcp_f32 v179, v179
    v_rcp_f32 v180, v180
    v_rcp_f32 v181, v181
    v_rcp_f32 v182, v182
    v_rcp_f32 v183, v183
    v_rcp_f32 v184, v184
    v_rcp_f32 v185, v185
    v_rcp_f32 v186, v186
    v_rcp_f32 v187, v187
    v_rcp_f32 v188, v188
    v_rcp_f32 v189, v189
    v_rcp_f32 v190, v190
    v_rcp_f32 v191, v191
    v_rcp_f32 v192, v192
    v_rcp_f32 v193, v193
    v_rcp_f32 v194, v194
    v_rcp_f32 v195, v195
    v_rcp_f32 v196, v196
    v_rcp_f32 v197, v197
    v_rcp_f32 v198, v198
    v_rcp_f32 v199, v199
    v_rcp_f32 v200, v200
    v_rcp_f32 v201, v201
    v_rcp_f32 v202, v202
    v_rcp_f32 v203, v203
    v_rcp_f32 v204, v204
    v_rcp_f32 v205, v205
    v_rcp_f32 v206, v206
    v_rcp_f32 v207, v207
    v_mul_f32 v144, v144, v176
    v_mul_f32 v145, v145, v177
    v_mul_f32 v146, v146, v178
    v_mul_f32 v147, v147, v179
    v_mul_f32 v148, v148, v180
    v_mul_f32 v149, v149, v181
    v_mul_f32 v150, v150, v182
    v_mul_f32 v151, v151, v183
    v_mul_f32 v152, v152, v184
    v_mul_f32 v153, v153, v185
    v_mul_f32 v154, v154, v186
    v_mul_f32 v155, v155, v187
    v_mul_f32 v156, v156, v188
    v_mul_f32 v157, v157, v189
    v_mul_f32 v158, v158, v190
    v_mul_f32 v159, v159, v191
    v_mul_f32 v160, v160, v192
    v_mul_f32 v161, v161, v193
    v_mul_f32 v162, v162, v194
    v_mul_f32 v163, v163, v195
    v_mul_f32 v164, v164, v196
    v_mul_f32 v165, v165, v197
    v_mul_f32 v166, v166, v198
    v_mul_f32 v167, v167, v199
    v_mul_f32 v168, v168, v200
    v_mul_f32 v169, v169, v201
    v_mul_f32 v170, v170, v202
    v_mul_f32 v171, v171, v203
    v_mul_f32 v172, v172, v204
    v_mul_f32 v173, v173, v205
    v_mul_f32 v174, v174, v206
    v_mul_f32 v175, v175, v207
    v_mov_b32 v12, 156032
    v_mov_b32 v13, 1
    s_waitcnt vmcnt(0)
    s_mov_b64 exec, 1
    ds_add_rtn_u32 v14, v12, v13
    s_mov_b64 exec, -1
    s_waitcnt lgkmcnt(0)
    v_readfirstlane_b32 s60, v14
    s_nop 0
    s_cmp_lg_u32 s60, 7
    s_cbranch_scc1 M_ARR0
    s_lshl_b32 s60, s65, 7
    s_add_u32 s60, s60, 5275648
    v_mov_b32 v12, s60
    v_mov_b32 v13, s33
    s_mov_b64 exec, 1
    global_store_dword v12, v13, s[18:19] sc1
    s_mov_b64 exec, -1
M_ARR0:
    s_sub_u32 s63, s25, 65536
    s_sub_u32 s62, s68, 8192
    s_add_u32 m0, s62, 0
    s_nop 0
    buffer_load_dwordx4 v4, s[40:43], s63 offen lds
    buffer_load_dwordx4 v5, s[40:43], s63 offen offset:1024 lds
    s_add_u32 s63, s63, 65536
    s_add_u32 m0, s62, 8192
    s_nop 0
    buffer_load_dwordx4 v4, s[40:43], s63 offen lds
    buffer_load_dwordx4 v5, s[40:43], s63 offen offset:1024 lds
    s_add_u32 s63, s63, 65536
    s_add_u32 m0, s62, 32768
    s_nop 0
    buffer_load_dwordx4 v4, s[40:43], s63 offen lds
    buffer_load_dwordx4 v5, s[40:43], s63 offen offset:1024 lds
    s_add_u32 s63, s63, 65536
    s_add_u32 m0, s62, 40960
    s_nop 0
    buffer_load_dwordx4 v4, s[40:43], s63 offen lds
    buffer_load_dwordx4 v5, s[40:43], s63 offen offset:1024 lds
    s_add_u32 s63, s63, 65536
    s_add_u32 m0, s62, 65536
    s_nop 0
    buffer_load_dwordx4 v4, s[40:43], s63 offen lds
    buffer_load_dwordx4 v5, s[40:43], s63 offen offset:1024 lds
    s_add_u32 s63, s63, 65536
    s_add_u32 m0, s62, 73728
    s_nop 0
    buffer_load_dwordx4 v4, s[40:43], s63 offen lds
    buffer_load_dwordx4 v5, s[40:43], s63 offen offset:1024 lds
    s_add_u32 s63, s63, 65536
    v_cvt_pk_bf16_f32 v12, v144, v145
    v_lshlrev_b32 v144, 16, v12
    v_and_b32 v145, 0xffff0000, v12
    v_lshlrev_b32 v176, 16, v212
    v_and_b32 v177, 0xffff0000, v212
    v_cvt_pk_bf16_f32 v12, v146, v147
    v_lshlrev_b32 v146, 16, v12
    v_and_b32 v147, 0xffff0000, v12
    v_lshlrev_b32 v178, 16, v213
    v_and_b32 v179, 0xffff0000, v213
    v_cvt_pk_bf16_f32 v12, v148, v149
    v_lshlrev_b32 v148, 16, v12
    v_and_b32 v149, 0xffff0000, v12
    v_lshlrev_b32 v180, 16, v214
    v_and_b32 v181, 0xffff0000, v214
    v_cvt_pk_bf16_f32 v12, v150, v151
    v_lshlrev_b32 v150, 16, v12
    v_and_b32 v151, 0xffff0000, v12
    v_lshlrev_b32 v182, 16, v215
    v_and_b32 v183, 0xffff0000, v215
    v_cvt_pk_bf16_f32 v12, v152, v153
    v_lshlrev_b32 v152, 16, v12
    v_and_b32 v153, 0xffff0000, v12
    v_lshlrev_b32 v184, 16, v216
    v_and_b32 v185, 0xffff0000, v216
    v_cvt_pk_bf16_f32 v12, v154, v155
    v_lshlrev_b32 v154, 16, v12
    v_and_b32 v155, 0xffff0000, v12
    v_lshlrev_b32 v186, 16, v217
    v_and_b32 v187, 0xffff0000, v217
    v_cvt_pk_bf16_f32 v12, v156, v157
    v_lshlrev_b32 v156, 16, v12
    v_and_b32 v157, 0xffff0000, v12
    v_lshlrev_b32 v188, 16, v218
    v_and_b32 v189, 0xffff0000, v218
    v_cvt_pk_bf16_f32 v12, v158, v159
    v_lshlrev_b32 v158, 16, v12
    v_and_b32 v159, 0xffff0000, v12
    v_lshlrev_b32 v190, 16, v219
    v_and_b32 v191, 0xffff0000, v219
    v_cvt_pk_bf16_f32 v12, v160, v161
    v_lshlrev_b32 v160, 16, v12
    v_and_b32 v161, 0xffff0000, v12
    v_lshlrev_b32 v192, 16, v220
    v_and_b32 v193, 0xffff0000, v220
    v_cvt_pk_bf16_f32 v12, v162, v163
    v_lshlrev_b32 v162, 16, v12
    v_and_b32 v163, 0xffff0000, v12
    v_lshlrev_b32 v194, 16, v221
    v_and_b32 v195, 0xffff0000, v221
    v_cvt_pk_bf16_f32 v12, v164, v165
    v_lshlrev_b32 v164, 16, v12
    v_and_b32 v165, 0xffff0000, v12
    v_lshlrev_b32 v196, 16, v222
    v_and_b32 v197, 0xffff0000, v222
    v_cvt_pk_bf16_f32 v12, v166, v167
    v_lshlrev_b32 v166, 16, v12
    v_and_b32 v167, 0xffff0000, v12
    v_lshlrev_b32 v198, 16, v223
    v_and_b32 v199, 0xffff0000, v223
    v_cvt_pk_bf16_f32 v12, v168, v169
    v_lshlrev_b32 v168, 16, v12
    v_and_b32 v169, 0xffff0000, v12
    v_lshlrev_b32 v200, 16, v224
    v_and_b32 v201, 0xffff0000, v224
    v_cvt_pk_bf16_f32 v12, v170, v171
    v_lshlrev_b32 v170, 16, v12
    v_and_b32 v171, 0xffff0000, v12
    v_lshlrev_b32 v202, 16, v225
    v_and_b32 v203, 0xffff0000, v225
    v_cvt_pk_bf16_f32 v12, v172, v173
    v_lshlrev_b32 v172, 16, v12
    v_and_b32 v173, 0xffff0000, v12
    v_lshlrev_b32 v204, 16, v226
    v_and_b32 v205, 0xffff0000, v226
    v_cvt_pk_bf16_f32 v12, v174, v175
    v_lshlrev_b32 v174, 16, v12
    v_and_b32 v175, 0xffff0000, v12
    v_lshlrev_b32 v206, 16, v227
    v_and_b32 v207, 0xffff0000, v227
    s_branch M_JOIN0
M_SEND0:
    s_mul_i32 s60, s31, 224
    s_mul_i32 s61, s29, 56
    s_add_u32 s60, s60, s61
    v_min_u32 v144, 55, v1
    v_add_lshl_u32 v144, v144, s60, 3
    v_add_u32 v144, 4259840, v144
    global_load_dwordx2 v[176:177], v144, s[18:19] sc1
    v_add_u32 v144, 28672, v144
    global_load_dwordx2 v[178:179], v144, s[18:19] sc1
    v_add_u32 v144, 28672, v144
    global_load_dwordx2 v[180:181], v144, s[18:19] sc1
    v_add_u32 v144, 28672, v144
    global_load_dwordx2 v[182:183], v144, s[18:19] sc1
    v_add_u32 v144, 28672, v144
    global_load_dwordx2 v[184:185], v144, s[18:19] sc1
    v_add_u32 v144, 28672, v144
    global_load_dwordx2 v[186:187], v144, s[18:19] sc1
    v_add_u32 v144, 28672, v144
    global_load_dwordx2 v[188:189], v144, s[18:19] sc1
    v_add_u32 v144, 28672, v144
    global_load_dwordx2 v[190:191], v144, s[18:19] sc1
    v_mov_b32 v12, 156032
    v_mov_b32 v13, 1
    s_waitcnt vmcnt(8)
    s_mov_b64 exec, 1
    ds_add_rtn_u32 v14, v12, v13
    s_mov_b64 exec, -1
    s_waitcnt lgkmcnt(0)
    v_readfirstlane_b32 s60, v14
    s_nop 0
    s_cmp_lg_u32 s60, 7
    s_cbranch_scc1 M_ARR3
    s_lshl_b32 s60, s65, 7
    s_add_u32 s60, s60, 5275648
    v_mov_b32 v12, s60
    v_mov_b32 v13, s33
    s_mov_b64 exec, 1
    global_store_dword v12, v13, s[18:19] sc1
    s_mov_b64 exec, -1
M_ARR3:
    s_mov_b32 s73, 20000
    s_mov_b32 s23, 1
    s_waitcnt vmcnt(0)
M_POLL2:
    v_xor_b32 v177, s33, v177
    v_xor_b32 v179, s33, v179
    v_xor_b32 v181, s33, v181
    v_xor_b32 v183, s33, v183
    v_xor_b32 v185, s33, v185
    v_xor_b32 v187, s33, v187
    v_xor_b32 v189, s33, v189
    v_xor_b32 v191, s33, v191
    v_or3_b32 v177, v177, v179, v181
    v_or3_b32 v183, v183, v185, v187
    v_or3_b32 v177, v177, v189, v191
    v_or_b32 v177, v177, v183
    v_cmp_ne_u32 vcc, 0, v177
    s_cbranch_vccz M_POLL2_OK
    s_cmp_lg_u32 s23, 0
    s_cbranch_scc1 M_ARR2
    s_mov_b32 s23, 1
    v_mov_b32 v12, 156032
    v_mov_b32 v13, 1
    s_waitcnt vmcnt(0)
    s_mov_b64 exec, 1
    ds_add_rtn_u32 v14, v12, v13
    s_mov_b64 exec, -1
    s_waitcnt lgkmcnt(0)
    v_readfirstlane_b32 s60, v14
    s_nop 0
    s_cmp_lg_u32 s60, 7
    s_cbranch_scc1 M_ARR2
    s_lshl_b32 s60, s65, 7
    s_add_u32 s60, s60, 5275648
    v_mov_b32 v12, s60
    v_mov_b32 v13, s33
    s_mov_b64 exec, 1
    global_store_dword v12, v13, s[18:19] sc1
    s_mov_b64 exec, -1
M_ARR2:
    s_sleep 10
    s_mul_i32 s60, s31, 224
    s_mul_i32 s61, s29, 56
    s_add_u32 s60, s60, s61
    v_min_u32 v144, 55, v1
    v_add_lshl_u32 v144, v144, s60, 3
    v_add_u32 v144, 4259840, v144
    global_load_dwordx2 v[176:177], v144, s[18:19] sc1
    v_add_u32 v144, 28672, v144
    global_load_dwordx2 v[178:179], v144, s[18:19] sc1
    v_add_u32 v144, 28672, v144
    global_load_dwordx2 v[180:181], v144, s[18:19] sc1
    v_add_u32 v144, 28672, v144
    global_load_dwordx2 v[182:183], v144, s[18:19] sc1
    v_add_u32 v144, 28672, v144
    global_load_dwordx2 v[184:185], v144, s[18:19] sc1
    v_add_u32 v144, 28672, v144
    global_load_dwordx2 v[186:187], v144, s[18:19] sc1
    v_add_u32 v144, 28672, v144
    global_load_dwordx2 v[188:189], v144, s[18:19] sc1
    v_add_u32 v144, 28672, v144
    global_load_dwordx2 v[190:191], v144, s[18:19] sc1
    s_waitcnt vmcnt(0)
    s_sub_u32 s73, s73, 1
    s_cmp_lg_u32 s73, 0
    s_cbranch_scc1 M_POLL2
M_POLL2_OK:
    v_mov_b32 v177, v178
    v_add_f32 v176, v176, v180
    v_add_f32 v177, v177, v182
    v_add_f32 v176, v176, v184
    v_add_f32 v177, v177, v186
    v_add_f32 v176, v176, v188
    v_add_f32 v177, v177, v190
    v_cvt_pk_bf16_f32 v176, v176, v176
    v_lshlrev_b32 v176, 16, v176
    v_cvt_pk_bf16_f32 v177, v177, v177
    v_lshlrev_b32 v177, 16, v177
    v_mul_f32 v178, 0xbfb8aa3b, v176
    v_exp_f32 v178, v178
    s_nop 0
    v_add_f32 v178, 1.0, v178
    v_rcp_f32 v178, v178
    s_nop 0
    v_mul_f32 v176, v176, v178
    v_cvt_pk_bf16_f32 v176, v176, v176
    v_lshlrev_b32 v176, 16, v176
    v_mul_f32 v176, v176, v177
    v_cvt_pk_bf16_f32 v176, v176, v176
    v_lshlrev_b32 v176, 16, v176
    s_lshl_b32 s60, s29, 8
    s_add_u32 s60, s60, 148480
    v_lshlrev_b32 v12, 2, v1
    v_add_u32 v12, s60, v12
    ds_write_b32 v12, v176
    v_lshrrev_b32 v13, 3, v1
    v_lshlrev_b32 v13, 2, v13
    v_add_u32 v13, s60, v13
    s_waitcnt lgkmcnt(0)
    ds_read_b32 v176, v13 offset:0
    ds_read_b32 v177, v13 offset:32
    ds_read_b32 v178, v13 offset:64
    ds_read_b32 v179, v13 offset:96
    ds_read_b32 v180, v13 offset:128
    ds_read_b32 v181, v13 offset:160
    ds_read_b32 v182, v13 offset:192
    s_waitcnt lgkmcnt(0)
    v_lshlrev_b32 v160, 16, v212
    v_and_b32 v161, 0xffff0000, v212
    v_mul_f32 v152, v160, v176
    v_mul_f32 v153, v161, v176
    v_lshlrev_b32 v160, 16, v213
    v_and_b32 v161, 0xffff0000, v213
    v_mul_f32 v154, v160, v176
    v_mul_f32 v155, v161, v176
    v_lshlrev_b32 v160, 16, v214
    v_and_b32 v161, 0xffff0000, v214
    v_mul_f32 v156, v160, v176
    v_mul_f32 v157, v161, v176
    v_lshlrev_b32 v160, 16, v215
    v_and_b32 v161, 0xffff0000, v215
    v_mul_f32 v158, v160, v176
    v_mul_f32 v159, v161, v176
    v_lshlrev_b32 v160, 16, v216
    v_and_b32 v161, 0xffff0000, v216
    v_fmac_f32 v152, v160, v177
    v_fmac_f32 v153, v161, v177
    v_lshlrev_b32 v160, 16, v217
    v_and_b32 v161, 0xffff0000, v217
    v_fmac_f32 v154, v160, v177
    v_fmac_f32 v155, v161, v177
    v_lshlrev_b32 v160, 16, v218
    v_and_b32 v161, 0xffff0000, v218
    v_fmac_f32 v156, v160, v177
    v_fmac_f32 v157, v161, v177
    v_lshlrev_b32 v160, 16, v219
    v_and_b32 v161, 0xffff0000, v219
    v_fmac_f32 v158, v160, v177
    v_fmac_f32 v159, v161, v177
    v_lshlrev_b32 v160, 16, v220
    v_and_b32 v161, 0xffff0000, v220
    v_fmac_f32 v152, v160, v178
    v_fmac_f32 v153, v161, v178
    v_lshlrev_b32 v160, 16, v221
    v_and_b32 v161, 0xffff0000, v221
    v_fmac_f32 v154, v160, v178
    v_fmac_f32 v155, v161, v178
    v_lshlrev_b32 v160, 16, v222
    v_and_b32 v161, 0xffff0000, v222
    v_fmac_f32 v156, v160, v178
    v_fmac_f32 v157, v161, v178
    v_lshlrev_b32 v160, 16, v223
    v_and_b32 v161, 0xffff0000, v223
    v_fmac_f32 v158, v160, v178
    v_fmac_f32 v159, v161, v178
    v_lshlrev_b32 v160, 16, v224
    v_and_b32 v161, 0xffff0000, v224
    v_fmac_f32 v152, v160, v179
    v_fmac_f32 v153, v161, v179
    v_lshlrev_b32 v160, 16, v225
    v_and_b32 v161, 0xffff0000, v225
    v_fmac_f32 v154, v160, v179
    v_fmac_f32 v155, v161, v179
    v_lshlrev_b32 v160, 16, v226
    v_and_b32 v161, 0xffff0000, v226
    v_fmac_f32 v156, v160, v179
    v_fmac_f32 v157, v161, v179
    v_lshlrev_b32 v160, 16, v227
    v_and_b32 v161, 0xffff0000, v227
    v_fmac_f32 v158, v160, v179
    v_fmac_f32 v159, v161, v179
    v_lshlrev_b32 v160, 16, v228
    v_and_b32 v161, 0xffff0000, v228
    v_fmac_f32 v152, v160, v180
    v_fmac_f32 v153, v161, v180
    v_lshlrev_b32 v160, 16, v229
    v_and_b32 v161, 0xffff0000, v229
    v_fmac_f32 v154, v160, v180
    v_fmac_f32 v155, v161, v180
    v_lshlrev_b32 v160, 16, v230
    v_and_b32 v161, 0xffff0000, v230
    v_fmac_f32 v156, v160, v180
    v_fmac_f32 v157, v161, v180
    v_lshlrev_b32 v160, 16, v231
    v_and_b32 v161, 0xffff0000, v231
    v_fmac_f32 v158, v160, v180
    v_fmac_f32 v159, v161, v180
    v_lshlrev_b32 v160, 16, v232
    v_and_b32 v161, 0xffff0000, v232
    v_fmac_f32 v152, v160, v181
    v_fmac_f32 v153, v161, v181
    v_lshlrev_b32 v160, 16, v233
    v_and_b32 v161, 0xffff0000, v233
    v_fmac_f32 v154, v160, v181
    v_fmac_f32 v155, v161, v181
    v_lshlrev_b32 v160, 16, v234
    v_and_b32 v161, 0xffff0000, v234
    v_fmac_f32 v156, v160, v181
    v_fmac_f32 v157, v161, v181
    v_lshlrev_b32 v160, 16, v235
    v_and_b32 v161, 0xffff0000, v235
    v_fmac_f32 v158, v160, v181
    v_fmac_f32 v159, v161, v181
    v_lshlrev_b32 v160, 16, v236
    v_and_b32 v161, 0xffff0000, v236
    v_fmac_f32 v152, v160, v182
    v_fmac_f32 v153, v161, v182
    v_lshlrev_b32 v160, 16, v237
    v_and_b32 v161, 0xffff0000, v237
    v_fmac_f32 v154, v160, v182
    v_fmac_f32 v155, v161, v182
    v_lshlrev_b32 v160, 16, v238
    v_and_b32 v161, 0xffff0000, v238
    v_fmac_f32 v156, v160, v182
    v_fmac_f32 v157, v161, v182
    v_lshlrev_b32 v160, 16, v239
    v_and_b32 v161, 0xffff0000, v239
    v_fmac_f32 v158, v160, v182
    v_fmac_f32 v159, v161, v182
    v_add_f32_dpp v152, v152, v152 row_ror:8 row_mask:0xf bank_mask:0xf
    v_add_f32_dpp v153, v153, v153 row_ror:8 row_mask:0xf bank_mask:0xf
    v_add_f32_dpp v154, v154, v154 row_ror:8 row_mask:0xf bank_mask:0xf
    v_add_f32_dpp v155, v155, v155 row_ror:8 row_mask:0xf bank_mask:0xf
    v_add_f32_dpp v156, v156, v156 row_ror:8 row_mask:0xf bank_mask:0xf
    v_add_f32_dpp v157, v157, v157 row_ror:8 row_mask:0xf bank_mask:0xf
    v_add_f32_dpp v158, v158, v158 row_ror:8 row_mask:0xf bank_mask:0xf
    v_add_f32_dpp v159, v159, v159 row_ror:8 row_mask:0xf bank_mask:0xf
    v_mov_b32 v164, v152
    v_mov_b32 v165, v153
    v_mov_b32 v166, v154
    v_mov_b32 v167, v155
    v_mov_b32 v168, v156
    v_mov_b32 v169, v157
    v_mov_b32 v170, v158
    v_mov_b32 v171, v159
    v_permlane16_swap_b32 v152, v164
    v_permlane16_swap_b32 v153, v165
    v_permlane16_swap_b32 v154, v166
    v_permlane16_swap_b32 v155, v167
    v_permlane16_swap_b32 v156, v168
    v_permlane16_swap_b32 v157, v169
    v_permlane16_swap_b32 v158, v170
    v_permlane16_swap_b32 v159, v171
    v_add_f32 v152, v152, v164
    v_add_f32 v153, v153, v165
    v_add_f32 v154, v154, v166
    v_add_f32 v155, v155, v167
    v_add_f32 v156, v156, v168
    v_add_f32 v157, v157, v169
    v_add_f32 v158, v158, v170
    v_add_f32 v159, v159, v171
    v_mov_b32 v164, v152
    v_mov_b32 v165, v153
    v_mov_b32 v166, v154
    v_mov_b32 v167, v155
    v_mov_b32 v168, v156
    v_mov_b32 v169, v157
    v_mov_b32 v170, v158
    v_mov_b32 v171, v159
    v_permlane32_swap_b32 v152, v164
    v_permlane32_swap_b32 v153, v165
    v_permlane32_swap_b32 v154, v166
    v_permlane32_swap_b32 v155, v167
    v_permlane32_swap_b32 v156, v168
    v_permlane32_swap_b32 v157, v169
    v_permlane32_swap_b32 v158, v170
    v_permlane32_swap_b32 v159, v171
    v_add_f32 v152, v152, v164
    v_add_f32 v153, v153, v165
    v_add_f32 v154, v154, v166
    v_add_f32 v155, v155, v167
    v_add_f32 v156, v156, v168
    v_add_f32 v157, v157, v169
    v_add_f32 v158, v158, v170
    v_add_f32 v159, v159, v171
    v_and_b32 v12, 7, v1
    v_lshlrev_b32 v12, 5, v12
    s_add_u32 s60, s60, 1024
    v_add_u32 v12, s60, v12
    ds_write_b128 v12, v[152:155]
    ds_write_b128 v12, v[156:159] offset:16
    v_mov_b32 v12, 157120
    v_mov_b32 v13, 1
    s_waitcnt lgkmcnt(0)
    s_mov_b64 exec, 1
    ds_add_rtn_u32 v14, v12, v13
    s_mov_b64 exec, -1
    s_waitcnt lgkmcnt(0)
    v_readfirstlane_b32 s60, v14
    s_nop 0
    s_cmp_lg_u32 s60, 3
    s_cbranch_scc1 M_SEND_END
    v_lshlrev_b32 v12, 2, v1
    v_add_u32 v13, 149504, v12
    ds_read_b32 v176, v13
    ds_read_b32 v177, v13 offset:256
    ds_read_b32 v178, v13 offset:512
    ds_read_b32 v179, v13 offset:768
    s_lshl_b32 s60, s31, 13
    s_lshl_b32 s61, s32, 9
    s_add_u32 s60, s60, s61
    s_add_u32 s60, s60, 4718592
    v_lshlrev_b32 v12, 1, v12
    v_add_u32 v12, s60, v12
    s_waitcnt lgkmcnt(0)
    v_add_f32 v176, v176, v177
    v_add_f32 v178, v178, v179
    v_add_f32 v176, v176, v178
    v_mov_b32 v177, s33
    global_store_dwordx2 v12, v[176:177], s[18:19] sc1
M_SEND_END:
    s_cmp_lg_u32 s23, 0
    s_cbranch_scc1 M_JOIN0
    v_mov_b32 v12, 156032
    v_mov_b32 v13, 1
    s_waitcnt vmcnt(0)
    s_mov_b64 exec, 1
    ds_add_rtn_u32 v14, v12, v13
    s_mov_b64 exec, -1
    s_waitcnt lgkmcnt(0)
    v_readfirstlane_b32 s60, v14
    s_nop 0
    s_cmp_lg_u32 s60, 7
    s_cbranch_scc1 M_ARR1
    s_lshl_b32 s60, s65, 7
    s_add_u32 s60, s60, 5275648
    v_mov_b32 v12, s60
    v_mov_b32 v13, s33
    s_mov_b64 exec, 1
    global_store_dword v12, v13, s[18:19] sc1
    s_mov_b64 exec, -1
M_ARR1:
M_JOIN0:
    s_add_u32 s25, s25, 393216
    s_lshr_b32 s60, s20, 1
    s_lshl_b32 s60, s60, 1
    s_add_u32 s60, s60, s28
    s_lshl_b32 s60, s60, 11
    s_add_u32 s60, s60, 5275648
    v_and_b32 v10, 15, v1
    v_lshlrev_b32 v10, 7, v10
    v_add_u32 v10, s60, v10
    global_load_dword v11, v10, s[18:19] sc1
    v_lshlrev_b32 v2, 4, v1
    v_add_u32 v3, 0x20000, v2
    s_mov_b32 s23, 0
    v_lshrrev_b32 v12, 4, v1
    v_and_b32 v13, 3, v1
    v_bfe_u32 v15, v1, 2, 2
    v_lshlrev_b32 v6, 11, v12
    v_lshl_add_u32 v6, v15, 6, v6
    v_lshl_add_u32 v6, v13, 4, v6
    s_lshl_b32 s60, s29, 8
    s_add_u32 s60, s60, 16384
    v_add_u32 v6, s60, v6
    v_add_u32 v7, 0x10000, v6
    s_lshl_b32 s60, s30, 12
    s_add_u32 s60, s60, 32768
    v_add_u32 v240, s60, v2
    v_add_u32 v241, 0x10000, v240
    v_mov_b32 v16, 0
    v_mov_b32 v17, 0
    v_mov_b32 v18, 0
    v_mov_b32 v19, 0
    v_mov_b32 v20, 0
    v_mov_b32 v21, 0
    v_mov_b32 v22, 0
    v_mov_b32 v23, 0
    v_mov_b32 v24, 0
    v_mov_b32 v25, 0
    v_mov_b32 v26, 0
    v_mov_b32 v27, 0
    v_mov_b32 v28, 0
    v_mov_b32 v29, 0
    v_mov_b32 v30, 0
    v_mov_b32 v31, 0
    v_mov_b32 v32, 0
    v_mov_b32 v33, 0
    v_mov_b32 v34, 0
    v_mov_b32 v35, 0
    v_mov_b32 v36, 0
    v_mov_b32 v37, 0
    v_mov_b32 v38, 0
    v_mov_b32 v39, 0
    v_mov_b32 v40, 0
    v_mov_b32 v41, 0
    v_mov_b32 v42, 0
    v_mov_b32 v43, 0
    v_mov_b32 v44, 0
    v_mov_b32 v45, 0
    v_mov_b32 v46, 0
    v_mov_b32 v47, 0
    s_mov_b32 s73, 20000
M_POLL1:
    s_waitcnt vmcnt(0)
    v_cmp_eq_u32 vcc, s33, v11
    s_nop 1
    s_and_b32 s26, vcc_lo, 0xffff
    s_and_b32 s60, s26, 0xf
    s_cmp_eq_u32 s60, 0xf
    s_cbranch_scc1 M_POLL1_OK
    s_sleep 2
    global_load_dword v11, v10, s[18:19] sc1
    s_sub_u32 s73, s73, 1
    s_cmp_lg_u32 s73, 0
    s_cbranch_scc1 M_POLL1
M_POLL1_OK:
    s_mov_b32 s27, 0x3f
    s_add_u32 m0, s69, 0
    s_nop 0
    buffer_load_dwordx4 v2, s[36:39], s24 offen sc1 lds
    s_add_u32 m0, s69, 8192
    s_nop 0
    buffer_load_dwordx4 v3, s[36:39], s24 offen sc1 lds
    s_add_u32 s24, s24, 262144
    s_add_u32 m0, s69, 32768
    s_nop 0
    buffer_load_dwordx4 v2, s[36:39], s24 offen sc1 lds
    s_add_u32 m0, s69, 40960
    s_nop 0
    buffer_load_dwordx4 v3, s[36:39], s24 offen sc1 lds
    s_add_u32 s24, s24, 262144
    s_add_u32 m0, s69, 65536
    s_nop 0
    buffer_load_dwordx4 v2, s[36:39], s24 offen sc1 lds
    s_add_u32 m0, s69, 73728
    s_nop 0
    buffer_load_dwordx4 v3, s[36:39], s24 offen sc1 lds
    s_add_u32 s24, s24, 262144
    s_waitcnt vmcnt(2)
    s_barrier
    ds_read_b64_tr_b16 v[48:49], v6 offset:0
    ds_read_b64_tr_b16 v[50:51], v6 offset:1024
    ds_read_b128 v[80:83], v240 offset:0
    ds_read_b64_tr_b16 v[52:53], v6 offset:8192
    ds_read_b64_tr_b16 v[54:55], v6 offset:9216
    ds_read_b128 v[84:87], v240 offset:8192
    ds_read_b64_tr_b16 v[56:57], v6 offset:8
    ds_read_b64_tr_b16 v[58:59], v6 offset:1032
    ds_read_b64_tr_b16 v[60:61], v6 offset:8200
    ds_read_b64_tr_b16 v[62:63], v6 offset:9224
    ds_read_b128 v[88:91], v240 offset:1024
    ds_read_b128 v[92:95], v240 offset:9216
.p2align 6
M_P3:
    s_waitcnt lgkmcnt(9)
    v_mfma_f32_16x16x32_bf16 v[16:19], v[48:51], v[80:83], v[16:19]
    ds_read_b128 v[96:99], v240 offset:2048
    s_waitcnt lgkmcnt(7)
    v_mfma_f32_16x16x32_bf16 v[16:19], v[52:55], v[84:87], v[16:19]
    ds_read_b128 v[100:103], v240 offset:10240
    s_add_u32 m0, s68, 98304
    s_nop 0
    buffer_load_dwordx4 v4, s[40:43], s25 offen lds
    s_waitcnt lgkmcnt(6)
    v_mfma_f32_16x16x32_bf16 v[20:23], v[56:59], v[80:83], v[20:23]
    ds_read_b128 v[104:107], v240 offset:3072
    s_waitcnt lgkmcnt(5)
    v_mfma_f32_16x16x32_bf16 v[20:23], v[60:63], v[84:87], v[20:23]
    ds_read_b128 v[108:111], v240 offset:11264
    s_waitcnt lgkmcnt(5)
    v_mfma_f32_16x16x32_bf16 v[24:27], v[48:51], v[88:91], v[24:27]
    ds_read_b64_tr_b16 v[64:65], v6 offset:32768
    s_waitcnt lgkmcnt(5)
    v_mfma_f32_16x16x32_bf16 v[24:27], v[52:55], v[92:95], v[24:27]
    ds_read_b64_tr_b16 v[66:67], v6 offset:33792
    s_add_u32 m0, s68, 98304
    s_nop 0
    buffer_load_dwordx4 v5, s[40:43], s25 offen offset:1024 lds
    s_add_u32 s25, s25, 131072
    v_mfma_f32_16x16x32_bf16 v[28:31], v[56:59], v[88:91], v[28:31]
    ds_read_b128 v[112:115], v240 offset:32768
    v_mfma_f32_16x16x32_bf16 v[28:31], v[60:63], v[92:95], v[28:31]
    ds_read_b64_tr_b16 v[68:69], v6 offset:40960
    s_waitcnt lgkmcnt(7)
    v_mfma_f32_16x16x32_bf16 v[32:35], v[48:51], v[96:99], v[32:35]
    ds_read_b64_tr_b16 v[70:71], v6 offset:41984
    s_waitcnt lgkmcnt(7)
    v_mfma_f32_16x16x32_bf16 v[32:35], v[52:55], v[100:103], v[32:35]
    ds_read_b128 v[116:119], v240 offset:40960
    s_add_u32 m0, s69, 98304
    s_nop 0
    buffer_load_dwordx4 v2, s[36:39], s24 offen sc1 lds
    v_mfma_f32_16x16x32_bf16 v[36:39], v[56:59], v[96:99], v[36:39]
    ds_read_b64_tr_b16 v[72:73], v6 offset:32776
    v_mfma_f32_16x16x32_bf16 v[36:39], v[60:63], v[100:103], v[36:39]
    ds_read_b64_tr_b16 v[74:75], v6 offset:33800
    s_waitcnt lgkmcnt(9)
    v_mfma_f32_16x16x32_bf16 v[40:43], v[48:51], v[104:107], v[40:43]
    ds_read_b64_tr_b16 v[76:77], v6 offset:40968
    s_waitcnt lgkmcnt(9)
    v_mfma_f32_16x16x32_bf16 v[40:43], v[52:55], v[108:111], v[40:43]
    ds_read_b64_tr_b16 v[78:79], v6 offset:41992
    s_add_u32 m0, s69, 106496
    s_nop 0
    buffer_load_dwordx4 v3, s[36:39], s24 offen sc1 lds
    s_add_u32 s24, s24, 262144
    v_mfma_f32_16x16x32_bf16 v[44:47], v[56:59], v[104:107], v[44:47]
    ds_read_b128 v[120:123], v240 offset:33792
    v_mfma_f32_16x16x32_bf16 v[44:47], v[60:63], v[108:111], v[44:47]
    ds_read_b128 v[124:127], v240 offset:41984
    s_waitcnt vmcnt(4)
    s_barrier
    s_waitcnt lgkmcnt(9)
    v_mfma_f32_16x16x32_bf16 v[16:19], v[64:67], v[112:115], v[16:19]
    ds_read_b128 v[128:131], v240 offset:34816
    s_waitcnt lgkmcnt(7)
    v_mfma_f32_16x16x32_bf16 v[16:19], v[68:71], v[116:119], v[16:19]
    ds_read_b128 v[132:135], v240 offset:43008
    s_add_u32 m0, s68, 0
    s_nop 0
    buffer_load_dwordx4 v4, s[40:43], s25 offen lds
    s_waitcnt lgkmcnt(6)
    v_mfma_f32_16x16x32_bf16 v[20:23], v[72:75], v[112:115], v[20:23]
    ds_read_b128 v[136:139], v240 offset:35840
    s_waitcnt lgkmcnt(5)
    v_mfma_f32_16x16x32_bf16 v[20:23], v[76:79], v[116:119], v[20:23]
    ds_read_b128 v[140:143], v240 offset:44032
    s_waitcnt lgkmcnt(5)
    v_mfma_f32_16x16x32_bf16 v[24:27], v[64:67], v[120:123], v[24:27]
    ds_read_b64_tr_b16 v[48:49], v7 offset:0
    s_waitcnt lgkmcnt(5)
    v_mfma_f32_16x16x32_bf16 v[24:27], v[68:71], v[124:127], v[24:27]
    ds_read_b64_tr_b16 v[50:51], v7 offset:1024
    s_add_u32 m0, s68, 0
    s_nop 0
    buffer_load_dwordx4 v5, s[40:43], s25 offen offset:1024 lds
    s_add_u32 s25, s25, 131072
    v_mfma_f32_16x16x32_bf16 v[28:31], v[72:75], v[120:123], v[28:31]
    ds_read_b128 v[80:83], v241 offset:0
    v_mfma_f32_16x16x32_bf16 v[28:31], v[76:79], v[124:127], v[28:31]
    ds_read_b64_tr_b16 v[52:53], v7 offset:8192
    s_waitcnt lgkmcnt(7)
    v_mfma_f32_16x16x32_bf16 v[32:35], v[64:67], v[128:131], v[32:35]
    ds_read_b64_tr_b16 v[54:55], v7 offset:9216
    s_waitcnt lgkmcnt(7)
    v_mfma_f32_16x16x32_bf16 v[32:35], v[68:71], v[132:135], v[32:35]
    ds_read_b128 v[84:87], v241 offset:8192
    s_add_u32 m0, s69, 0
    s_nop 0
    buffer_load_dwordx4 v2, s[36:39], s24 offen sc1 lds
    v_mfma_f32_16x16x32_bf16 v[36:39], v[72:75], v[128:131], v[36:39]
    ds_read_b64_tr_b16 v[56:57], v7 offset:8
    v_mfma_f32_16x16x32_bf16 v[36:39], v[76:79], v[132:135], v[36:39]
    ds_read_b64_tr_b16 v[58:59], v7 offset:1032
    s_waitcnt lgkmcnt(9)
    v_mfma_f32_16x16x32_bf16 v[40:43], v[64:67], v[136:139], v[40:43]
    ds_read_b64_tr_b16 v[60:61], v7 offset:8200
    s_waitcnt lgkmcnt(9)
    v_mfma_f32_16x16x32_bf16 v[40:43], v[68:71], v[140:143], v[40:43]
    ds_read_b64_tr_b16 v[62:63], v7 offset:9224
    s_add_u32 m0, s69, 8192
    s_nop 0
    buffer_load_dwordx4 v3, s[36:39], s24 offen sc1 lds
    s_add_u32 s24, s24, 262144
    v_mfma_f32_16x16x32_bf16 v[44:47], v[72:75], v[136:139], v[44:47]
    ds_read_b128 v[88:91], v241 offset:1024
    v_mfma_f32_16x16x32_bf16 v[44:47], v[76:79], v[140:143], v[44:47]
    ds_read_b128 v[92:95], v241 offset:9216
    s_waitcnt vmcnt(4)
    s_barrier
    s_waitcnt lgkmcnt(9)
    v_mfma_f32_16x16x32_bf16 v[16:19], v[48:51], v[80:83], v[16:19]
    ds_read_b128 v[96:99], v241 offset:2048
    s_waitcnt lgkmcnt(7)
    v_mfma_f32_16x16x32_bf16 v[16:19], v[52:55], v[84:87], v[16:19]
    ds_read_b128 v[100:103], v241 offset:10240
    s_add_u32 m0, s68, 32768
    s_nop 0
    buffer_load_dwordx4 v4, s[40:43], s25 offen lds
    s_waitcnt lgkmcnt(6)
    v_mfma_f32_16x16x32_bf16 v[20:23], v[56:59], v[80:83], v[20:23]
    ds_read_b128 v[104:107], v241 offset:3072
    s_waitcnt lgkmcnt(5)
    v_mfma_f32_16x16x32_bf16 v[20:23], v[60:63], v[84:87], v[20:23]
    ds_read_b128 v[108:111], v241 offset:11264
    s_waitcnt lgkmcnt(5)
    v_mfma_f32_16x16x32_bf16 v[24:27], v[48:51], v[88:91], v[24:27]
    ds_read_b64_tr_b16 v[64:65], v7 offset:32768
    s_waitcnt lgkmcnt(5)
    v_mfma_f32_16x16x32_bf16 v[24:27], v[52:55], v[92:95], v[24:27]
    ds_read_b64_tr_b16 v[66:67], v7 offset:33792
    s_add_u32 m0, s68, 32768
    s_nop 0
    buffer_load_dwordx4 v5, s[40:43], s25 offen offset:1024 lds
    s_add_u32 s25, s25, 131072
    v_mfma_f32_16x16x32_bf16 v[28:31], v[56:59], v[88:91], v[28:31]
    ds_read_b128 v[112:115], v241 offset:32768
    v_mfma_f32_16x16x32_bf16 v[28:31], v[60:63], v[92:95], v[28:31]
    ds_read_b64_tr_b16 v[68:69], v7 offset:40960
    s_waitcnt lgkmcnt(7)
    v_mfma_f32_16x16x32_bf16 v[32:35], v[48:51], v[96:99], v[32:35]
    ds_read_b64_tr_b16 v[70:71], v7 offset:41984
    s_waitcnt lgkmcnt(7)
    v_mfma_f32_16x16x32_bf16 v[32:35], v[52:55], v[100:103], v[32:35]
    ds_read_b128 v[116:119], v241 offset:40960
    s_add_u32 m0, s69, 32768
    s_nop 0
    buffer_load_dwordx4 v2, s[36:39], s24 offen sc1 lds
    v_mfma_f32_16x16x32_bf16 v[36:39], v[56:59], v[96:99], v[36:39]
    ds_read_b64_tr_b16 v[72:73], v7 offset:32776
    v_mfma_f32_16x16x32_bf16 v[36:39], v[60:63], v[100:103], v[36:39]
    ds_read_b64_tr_b16 v[74:75], v7 offset:33800
    s_waitcnt lgkmcnt(9)
    v_mfma_f32_16x16x32_bf16 v[40:43], v[48:51], v[104:107], v[40:43]
    ds_read_b64_tr_b16 v[76:77], v7 offset:40968
    s_waitcnt lgkmcnt(9)
    v_mfma_f32_16x16x32_bf16 v[40:43], v[52:55], v[108:111], v[40:43]
    ds_read_b64_tr_b16 v[78:79], v7 offset:41992
    s_add_u32 m0, s69, 40960
    s_nop 0
    buffer_load_dwordx4 v3, s[36:39], s24 offen sc1 lds
    s_add_u32 s24, s24, 262144
    v_mfma_f32_16x16x32_bf16 v[44:47], v[56:59], v[104:107], v[44:47]
    ds_read_b128 v[120:123], v241 offset:33792
    v_mfma_f32_16x16x32_bf16 v[44:47], v[60:63], v[108:111], v[44:47]
    ds_read_b128 v[124:127], v241 offset:41984
    s_waitcnt vmcnt(4)
    s_barrier
    s_waitcnt lgkmcnt(9)
    v_mfma_f32_16x16x32_bf16 v[16:19], v[64:67], v[112:115], v[16:19]
    ds_read_b128 v[128:131], v241 offset:34816
    s_waitcnt lgkmcnt(7)
    v_mfma_f32_16x16x32_bf16 v[16:19], v[68:71], v[116:119], v[16:19]
    ds_read_b128 v[132:135], v241 offset:43008
    s_add_u32 m0, s68, 65536
    s_nop 0
    buffer_load_dwordx4 v4, s[40:43], s25 offen lds
    s_waitcnt lgkmcnt(6)
    v_mfma_f32_16x16x32_bf16 v[20:23], v[72:75], v[112:115], v[20:23]
    ds_read_b128 v[136:139], v241 offset:35840
    s_waitcnt lgkmcnt(5)
    v_mfma_f32_16x16x32_bf16 v[20:23], v[76:79], v[116:119], v[20:23]
    ds_read_b128 v[140:143], v241 offset:44032
    s_waitcnt lgkmcnt(5)
    v_mfma_f32_16x16x32_bf16 v[24:27], v[64:67], v[120:123], v[24:27]
    ds_read_b64_tr_b16 v[48:49], v6 offset:0
    s_waitcnt lgkmcnt(5)
    v_mfma_f32_16x16x32_bf16 v[24:27], v[68:71], v[124:127], v[24:27]
    ds_read_b64_tr_b16 v[50:51], v6 offset:1024
    s_add_u32 m0, s68, 65536
    s_nop 0
    buffer_load_dwordx4 v5, s[40:43], s25 offen offset:1024 lds
    s_add_u32 s25, s25, 131072
    v_mfma_f32_16x16x32_bf16 v[28:31], v[72:75], v[120:123], v[28:31]
    ds_read_b128 v[80:83], v240 offset:0
    v_mfma_f32_16x16x32_bf16 v[28:31], v[76:79], v[124:127], v[28:31]
    ds_read_b64_tr_b16 v[52:53], v6 offset:8192
    s_waitcnt lgkmcnt(7)
    v_mfma_f32_16x16x32_bf16 v[32:35], v[64:67], v[128:131], v[32:35]
    ds_read_b64_tr_b16 v[54:55], v6 offset:9216
    s_waitcnt lgkmcnt(7)
    v_mfma_f32_16x16x32_bf16 v[32:35], v[68:71], v[132:135], v[32:35]
    ds_read_b128 v[84:87], v240 offset:8192
    s_add_u32 m0, s69, 65536
    s_nop 0
    buffer_load_dwordx4 v2, s[36:39], s24 offen sc1 lds
    v_mfma_f32_16x16x32_bf16 v[36:39], v[72:75], v[128:131], v[36:39]
    ds_read_b64_tr_b16 v[56:57], v6 offset:8
    v_mfma_f32_16x16x32_bf16 v[36:39], v[76:79], v[132:135], v[36:39]
    ds_read_b64_tr_b16 v[58:59], v6 offset:1032
    s_waitcnt lgkmcnt(9)
    v_mfma_f32_16x16x32_bf16 v[40:43], v[64:67], v[136:139], v[40:43]
    ds_read_b64_tr_b16 v[60:61], v6 offset:8200
    s_waitcnt lgkmcnt(9)
    v_mfma_f32_16x16x32_bf16 v[40:43], v[68:71], v[140:143], v[40:43]
    ds_read_b64_tr_b16 v[62:63], v6 offset:9224
    s_add_u32 m0, s69, 73728
    s_nop 0
    buffer_load_dwordx4 v3, s[36:39], s24 offen sc1 lds
    s_add_u32 s24, s24, 262144
    v_mfma_f32_16x16x32_bf16 v[44:47], v[72:75], v[136:139], v[44:47]
    ds_read_b128 v[88:91], v240 offset:1024
    v_mfma_f32_16x16x32_bf16 v[44:47], v[76:79], v[140:143], v[44:47]
    ds_read_b128 v[92:95], v240 offset:9216
    s_and_b32 s60, s26, s27
    s_cmp_lg_u32 s60, s27
    s_cbranch_scc1 M_RP
M_RP_RET:
    s_lshl_b32 s27, s27, 2
    s_or_b32 s27, s27, 3
    s_and_b32 s27, s27, 0xffff
    s_add_u32 s23, s23, 1
    s_cmp_lt_u32 s23, 8
    s_waitcnt vmcnt(4)
    s_barrier
    s_cbranch_scc1 M_P3
    s_cmp_eq_u32 s30, s28
    s_cselect_b32 s60, 1, 0
    s_xor_b32 s60, s2, s60
    s_lshl_b32 s60, s60, 2
    s_add_u32 s60, s60, s29
    s_lshl_b32 s61, s60, 13
    s_add_u32 s61, s61, 33554432
    v_add_u32 v10, s61, v2
    v_add_u32 v11, 4096, v10
    s_lshl_b32 s60, s60, 7
    s_add_u32 s60, s60, 5636096
    v_mov_b32 v14, s60
    v_mov_b32 v15, s33
    s_cmp_eq_u32 s30, s28
    s_cbranch_scc1 M_KEEP1
    global_store_dwordx4 v10, v[16:19], s[18:19] offset:0 sc1
    global_store_dwordx4 v10, v[20:23], s[18:19] offset:1024 sc1
    global_store_dwordx4 v10, v[24:27], s[18:19] offset:2048 sc1
    global_store_dwordx4 v10, v[28:31], s[18:19] offset:3072 sc1
    global_store_dwordx4 v11, v[32:35], s[18:19] offset:0 sc1
    global_store_dwordx4 v11, v[36:39], s[18:19] offset:1024 sc1
    global_store_dwordx4 v11, v[40:43], s[18:19] offset:2048 sc1
    global_store_dwordx4 v11, v[44:47], s[18:19] offset:3072 sc1
    s_waitcnt vmcnt(0)
    s_mov_b64 exec, 1
    global_store_dword v14, v15, s[18:19] sc1
    s_mov_b64 exec, -1
    s_branch K2_END
M_RP:
    s_mov_b32 s73, 20000
M_RP_L:
    global_load_dword v11, v10, s[18:19] sc1
    s_waitcnt vmcnt(0)
    v_cmp_eq_u32 vcc, s33, v11
    s_nop 1
    s_and_b32 s26, vcc_lo, 0xffff
    s_and_b32 s60, s26, s27
    s_cmp_eq_u32 s60, s27
    s_cbranch_scc1 M_RP_RET
    s_sleep 2
    s_sub_u32 s73, s73, 1
    s_cmp_lg_u32 s73, 0
    s_cbranch_scc1 M_RP_L
    s_branch M_RP_RET
M_KEEP1:
    s_waitcnt lgkmcnt(0)
    s_lshl_b32 s60, s20, 1
    s_add_u32 s60, s60, s28
    s_lshr_b32 s61, s35, 6
    s_cmp_lg_u32 s60, s61
    s_cbranch_scc1 M_H5
    s_mov_b32 s73, 20000
M_POLL3:
    s_lshl_b32 s60, s21, 2
    s_add_u32 s60, s60, s29
    s_lshl_b32 s60, s60, 8
    s_add_u32 s60, s60, 4718592
    v_and_b32 v70, 15, v1
    v_lshlrev_b32 v70, 4, v70
    v_lshrrev_b32 v71, 4, v1
    v_lshl_add_u32 v70, v71, 15, v70
    v_add_u32 v70, s60, v70
    global_load_dwordx4 v[48:51], v70, s[18:19] sc1
    v_add_u32 v70, 8192, v70
    global_load_dwordx4 v[52:55], v70, s[18:19] sc1
    v_add_u32 v70, 8192, v70
    global_load_dwordx4 v[56:59], v70, s[18:19] sc1
    v_add_u32 v70, 8192, v70
    global_load_dwordx4 v[60:63], v70, s[18:19] sc1
    s_waitcnt vmcnt(0)
    v_mov_b32 v71, 0
    v_xor_b32 v49, s33, v49
    v_xor_b32 v51, s33, v51
    v_or3_b32 v71, v71, v49, v51
    v_xor_b32 v53, s33, v53
    v_xor_b32 v55, s33, v55
    v_or3_b32 v71, v71, v53, v55
    v_xor_b32 v57, s33, v57
    v_xor_b32 v59, s33, v59
    v_or3_b32 v71, v71, v57, v59
    v_xor_b32 v61, s33, v61
    v_xor_b32 v63, s33, v63
    v_or3_b32 v71, v71, v61, v63
    v_cmp_ne_u32 vcc, 0, v71
    s_cbranch_vccz M_POLL3_OK
    s_sleep 10
    s_sub_u32 s73, s73, 1
    s_cmp_lg_u32 s73, 0
    s_cbranch_scc1 M_POLL3
M_POLL3_OK:
    s_lshr_b32 s60, s35, 4
    s_lshl_b32 s60, s60, 15
    s_lshl_b32 s61, s21, 2
    s_add_u32 s61, s61, s29
    s_lshl_b32 s61, s61, 10
    s_add_u32 s60, s60, s61
    s_and_b32 s61, s35, 15
    s_lshl_b32 s61, s61, 4
    s_add_u32 s60, s60, s61
    v_bfe_u32 v70, v1, 2, 2
    v_lshlrev_b32 v70, 8, v70
    v_and_b32 v71, 3, v1
    v_lshl_add_u32 v70, v71, 2, v70
    v_add_u32 v70, s60, v70
    global_load_dword v72, v70, s[18:19] sc1
    s_and_b32 s60, s34, 0xffff0000
    s_ashr_i32 s61, s60, 31
    s_not_b32 s61, s61
    s_or_b32 s61, s61, 0x80000000
    s_xor_b32 s60, s60, s61
    s_and_b32 s60, s60, 0xffff0000
    v_mov_b32 v73, s60
    v_mul_f32 v73, 0xbfb8aa3b, v73
    v_exp_f32 v73, v73
    s_nop 0
    v_add_f32 v73, 1.0, v73
    v_rcp_f32 v73, v73
    s_nop 0
    v_cvt_pk_bf16_f32 v73, v73, v73
    v_lshlrev_b32 v73, 16, v73
    v_mov_b32 v64, v48
    v_mov_b32 v65, v50
    v_add_f32 v64, v64, v52
    v_add_f32 v65, v65, v54
    v_add_f32 v64, v64, v56
    v_add_f32 v65, v65, v58
    v_add_f32 v64, v64, v60
    v_add_f32 v65, v65, v62
    v_mov_b32 v66, v64
    v_mov_b32 v67, v65
    s_nop 0
    v_permlane16_swap_b32 v64, v66
    v_permlane16_swap_b32 v65, v67
    v_add_f32 v64, v64, v66
    v_add_f32 v65, v65, v67
    v_mov_b32 v66, v64
    v_mov_b32 v67, v65
    s_nop 0
    v_permlane32_swap_b32 v64, v66
    v_permlane32_swap_b32 v65, v67
    v_add_f32 v64, v64, v66
    v_add_f32 v65, v65, v67
    s_waitcnt vmcnt(0)
    v_lshlrev_b32 v66, 16, v72
    v_and_b32 v67, 0xffff0000, v72
    v_cvt_pk_bf16_f32 v64, v64, v64
    v_lshlrev_b32 v64, 16, v64
    v_mul_f32 v64, v64, v73
    v_cvt_pk_bf16_f32 v64, v64, v64
    v_lshlrev_b32 v64, 16, v64
    v_add_f32 v64, v64, v66
    v_cvt_pk_bf16_f32 v64, v64, v64
    v_lshlrev_b32 v64, 16, v64
    v_mul_f32 v68, 0xbfb8aa3b, v64
    v_exp_f32 v68, v68
    s_nop 0
    v_add_f32 v68, 1.0, v68
    v_rcp_f32 v68, v68
    s_nop 0
    v_mul_f32 v64, v64, v68
    v_cvt_pk_bf16_f32 v64, v64, v64
    v_lshlrev_b32 v64, 16, v64
    v_cvt_pk_bf16_f32 v65, v65, v65
    v_lshlrev_b32 v65, 16, v65
    v_mul_f32 v65, v65, v73
    v_cvt_pk_bf16_f32 v65, v65, v65
    v_lshlrev_b32 v65, 16, v65
    v_add_f32 v65, v65, v67
    v_cvt_pk_bf16_f32 v65, v65, v65
    v_lshlrev_b32 v65, 16, v65
    v_mul_f32 v69, 0xbfb8aa3b, v65
    v_exp_f32 v69, v69
    s_nop 0
    v_add_f32 v69, 1.0, v69
    v_rcp_f32 v69, v69
    s_nop 0
    v_mul_f32 v65, v65, v69
    v_cvt_pk_bf16_f32 v65, v65, v65
    v_lshlrev_b32 v65, 16, v65
    s_lshl_b32 s60, s29, 7
    s_add_u32 s60, s60, 152576
    v_and_b32 v70, 15, v1
    v_lshlrev_b32 v71, 3, v70
    v_add_u32 v71, s60, v71
    ds_write_b64 v71, v[64:65]
    v_lshrrev_b32 v71, 4, v1
    v_lshlrev_b32 v71, 5, v71
    v_add_u32 v71, s60, v71
    s_and_b32 s60, s35, 63
    s_waitcnt lgkmcnt(0)
    ds_read_b128 v[48:51], v71
    ds_read_b128 v[52:55], v71 offset:16
    s_waitcnt lgkmcnt(0)
    v_add_u32 v71, 0, v70
    v_cmp_eq_u32 vcc, s60, v71
    s_nop 1
    v_cndmask_b32 v144, v144, v48, vcc
    v_cndmask_b32 v145, v145, v49, vcc
    v_cndmask_b32 v146, v146, v50, vcc
    v_cndmask_b32 v147, v147, v51, vcc
    v_cndmask_b32 v148, v148, v52, vcc
    v_cndmask_b32 v149, v149, v53, vcc
    v_cndmask_b32 v150, v150, v54, vcc
    v_cndmask_b32 v151, v151, v55, vcc
    v_add_u32 v71, 16, v70
    v_cmp_eq_u32 vcc, s60, v71
    s_nop 1
    v_cndmask_b32 v152, v152, v48, vcc
    v_cndmask_b32 v153, v153, v49, vcc
    v_cndmask_b32 v154, v154, v50, vcc
    v_cndmask_b32 v155, v155, v51, vcc
    v_cndmask_b32 v156, v156, v52, vcc
    v_cndmask_b32 v157, v157, v53, vcc
    v_cndmask_b32 v158, v158, v54, vcc
    v_cndmask_b32 v159, v159, v55, vcc
    v_add_u32 v71, 32, v70
    v_cmp_eq_u32 vcc, s60, v71
    s_nop 1
    v_cndmask_b32 v160, v160, v48, vcc
    v_cndmask_b32 v161, v161, v49, vcc
    v_cndmask_b32 v162, v162, v50, vcc
    v_cndmask_b32 v163, v163, v51, vcc
    v_cndmask_b32 v164, v164, v52, vcc
    v_cndmask_b32 v165, v165, v53, vcc
    v_cndmask_b32 v166, v166, v54, vcc
    v_cndmask_b32 v167, v167, v55, vcc
    v_add_u32 v71, 48, v70
    v_cmp_eq_u32 vcc, s60, v71
    s_nop 1
    v_cndmask_b32 v168, v168, v48, vcc
    v_cndmask_b32 v169, v169, v49, vcc
    v_cndmask_b32 v170, v170, v50, vcc
    v_cndmask_b32 v171, v171, v51, vcc
    v_cndmask_b32 v172, v172, v52, vcc
    v_cndmask_b32 v173, v173, v53, vcc
    v_cndmask_b32 v174, v174, v54, vcc
    v_cndmask_b32 v175, v175, v55, vcc
M_H5:
    s_mov_b32 s73, 20000
M_POLL4:
    global_load_dword v15, v14, s[18:19] sc1
    s_waitcnt vmcnt(0)
    v_cmp_ne_u32 vcc, s33, v15
    s_cbranch_vccz M_POLL4_OK
    s_sleep 1
    s_sub_u32 s73, s73, 1
    s_cmp_lg_u32 s73, 0
    s_cbranch_scc1 M_POLL4
M_POLL4_OK:
    global_load_dwordx4 v[208:211], v10, s[18:19] offset:0 sc1
    global_load_dwordx4 v[212:215], v10, s[18:19] offset:1024 sc1
    global_load_dwordx4 v[216:219], v10, s[18:19] offset:2048 sc1
    global_load_dwordx4 v[220:223], v10, s[18:19] offset:3072 sc1
    global_load_dwordx4 v[224:227], v11, s[18:19] offset:0 sc1
    global_load_dwordx4 v[228:231], v11, s[18:19] offset:1024 sc1
    global_load_dwordx4 v[232:235], v11, s[18:19] offset:2048 sc1
    global_load_dwordx4 v[236:239], v11, s[18:19] offset:3072 sc1
    s_waitcnt vmcnt(6)
    v_add_f32 v16, v16, v208
    v_add_f32 v17, v17, v209
    v_add_f32 v18, v18, v210
    v_add_f32 v19, v19, v211
    v_add_f32 v20, v20, v212
    v_add_f32 v21, v21, v213
    v_add_f32 v22, v22, v214
    v_add_f32 v23, v23, v215
    v_fmac_f32 v176, v16, v144
    v_fmac_f32 v177, v17, v145
    v_fmac_f32 v178, v18, v146
    v_fmac_f32 v179, v19, v147
    v_fmac_f32 v180, v20, v148
    v_fmac_f32 v181, v21, v149
    v_fmac_f32 v182, v22, v150
    v_fmac_f32 v183, v23, v151
    v_cvt_pk_bf16_f32 v48, v176, v177
    v_cvt_pk_bf16_f32 v49, v178, v179
    v_cvt_pk_bf16_f32 v50, v180, v181
    v_cvt_pk_bf16_f32 v51, v182, v183
    global_store_dwordx4 v9, v[48:51], s[78:79] sc1
    v_add_u32 v9, 0x8000, v9
    s_waitcnt vmcnt(5)
    v_add_f32 v24, v24, v216
    v_add_f32 v25, v25, v217
    v_add_f32 v26, v26, v218
    v_add_f32 v27, v27, v219
    v_add_f32 v28, v28, v220
    v_add_f32 v29, v29, v221
    v_add_f32 v30, v30, v222
    v_add_f32 v31, v31, v223
    v_fmac_f32 v184, v24, v152
    v_fmac_f32 v185, v25, v153
    v_fmac_f32 v186, v26, v154
    v_fmac_f32 v187, v27, v155
    v_fmac_f32 v188, v28, v156
    v_fmac_f32 v189, v29, v157
    v_fmac_f32 v190, v30, v158
    v_fmac_f32 v191, v31, v159
    v_cvt_pk_bf16_f32 v52, v184, v185
    v_cvt_pk_bf16_f32 v53, v186, v187
    v_cvt_pk_bf16_f32 v54, v188, v189
    v_cvt_pk_bf16_f32 v55, v190, v191
    global_store_dwordx4 v9, v[52:55], s[78:79] sc1
    v_add_u32 v9, 0x8000, v9
    s_waitcnt vmcnt(4)
    v_add_f32 v32, v32, v224
    v_add_f32 v33, v33, v225
    v_add_f32 v34, v34, v226
    v_add_f32 v35, v35, v227
    v_add_f32 v36, v36, v228
    v_add_f32 v37, v37, v229
    v_add_f32 v38, v38, v230
    v_add_f32 v39, v39, v231
    v_fmac_f32 v192, v32, v160
    v_fmac_f32 v193, v33, v161
    v_fmac_f32 v194, v34, v162
    v_fmac_f32 v195, v35, v163
    v_fmac_f32 v196, v36, v164
    v_fmac_f32 v197, v37, v165
    v_fmac_f32 v198, v38, v166
    v_fmac_f32 v199, v39, v167
    v_cvt_pk_bf16_f32 v56, v192, v193
    v_cvt_pk_bf16_f32 v57, v194, v195
    v_cvt_pk_bf16_f32 v58, v196, v197
    v_cvt_pk_bf16_f32 v59, v198, v199
    global_store_dwordx4 v9, v[56:59], s[78:79] sc1
    v_add_u32 v9, 0x8000, v9
    s_waitcnt vmcnt(3)
    v_add_f32 v40, v40, v232
    v_add_f32 v41, v41, v233
    v_add_f32 v42, v42, v234
    v_add_f32 v43, v43, v235
    v_add_f32 v44, v44, v236
    v_add_f32 v45, v45, v237
    v_add_f32 v46, v46, v238
    v_add_f32 v47, v47, v239
    v_fmac_f32 v200, v40, v168
    v_fmac_f32 v201, v41, v169
    v_fmac_f32 v202, v42, v170
    v_fmac_f32 v203, v43, v171
    v_fmac_f32 v204, v44, v172
    v_fmac_f32 v205, v45, v173
    v_fmac_f32 v206, v46, v174
    v_fmac_f32 v207, v47, v175
    v_cvt_pk_bf16_f32 v60, v200, v201
    v_cvt_pk_bf16_f32 v61, v202, v203
    v_cvt_pk_bf16_f32 v62, v204, v205
    v_cvt_pk_bf16_f32 v63, v206, v207
    global_store_dwordx4 v9, v[60:63], s[78:79] sc1
K2_END:
    s_endpgm
M_SSPIN:
    s_sleep 2
    s_lshl_b32 s60, s21, 3
    s_add_u32 s60, s60, s3
    s_lshl_b32 s60, s60, 8
    s_add_u32 s60, s60, 5373952
    v_and_b32 v12, 15, v1
    v_lshlrev_b32 v12, 3, v12
    v_add_u32 v12, s60, v12
    global_load_dwordx2 v[250:251], v12, s[18:19] sc1
    global_load_dwordx2 v[252:253], v12, s[18:19] offset:128 sc1
    s_lshl_b32 s60, s20, 13
    s_lshl_b32 s61, s3, 7
    s_add_u32 s60, s60, s61
    s_add_u32 s60, s60, 5439488
    v_lshrrev_b32 v13, 3, v1
    v_lshlrev_b32 v13, 10, v13
    v_and_b32 v14, 7, v1
    v_lshl_add_u32 v13, v14, 4, v13
    v_add_u32 v13, s60, v13
    global_load_dwordx4 v[208:211], v13, s[18:19] sc1
    s_waitcnt vmcnt(0)
    v_xor_b32 v12, s33, v251
    v_xor_b32 v13, s33, v253
    v_xor_b32 v14, s33, v209
    v_xor_b32 v15, s33, v211
    v_or3_b32 v12, v12, v13, v14
    v_or_b32 v12, v12, v15
    v_cmp_ne_u32 vcc, 0, v12
    s_cbranch_vccz M_SSPIN_RET
    s_sub_u32 s73, s73, 1
    s_cmp_lg_u32 s73, 0
    s_cbranch_scc1 M_SSPIN
    s_branch M_SSPIN_RET
M_KSPIN:
    s_sleep 2
    v_lshlrev_b32 v14, 5, v1
    v_add_u32 v14, 4194304, v14
    global_load_dwordx4 v[244:247], v14, s[18:19] sc1
    global_load_dwordx4 v[248:251], v14, s[18:19] offset:16 sc1
    s_waitcnt vmcnt(0)
    v_xor_b32 v245, s33, v245
    v_xor_b32 v247, s33, v247
    v_xor_b32 v249, s33, v249
    v_xor_b32 v251, s33, v251
    v_or3_b32 v245, v245, v247, v249
    v_or_b32 v245, v245, v251
    v_cmp_ne_u32 vcc, 0, v245
    s_cbranch_vccz M_KSPIN_RET
    s_sub_u32 s73, s73, 1
    s_cmp_lg_u32 s73, 0
    s_cbranch_scc1 M_KSPIN
    s_branch M_KSPIN_RET
K2_SLOW:
    s_waitcnt vmcnt(0) lgkmcnt(0)
    v_and_b32 v12, 31, v1
    v_lshlrev_b32 v12, 8, v12
    v_lshrrev_b32 v13, 5, v1
    v_lshl_add_u32 v12, v13, 4, v12
    v_and_b32 v14, 19, v1
    v_bfe_u32 v15, v1, 2, 1
    v_lshl_add_u32 v14, v15, 3, v14
    v_bfe_u32 v15, v1, 3, 1
    v_lshl_add_u32 v14, v15, 2, v14
    v_lshlrev_b32 v14, 1, v14
    v_lshl_add_u32 v14, v13, 10, v14
    v_mov_b32 v13, 0xff800000
    s_mov_b32 s61, 0
K2_SLOW_L1:
    buffer_load_dwordx4 v[176:179], v12, s[44:47], s61 offen offset:0
    buffer_load_dwordx4 v[180:183], v12, s[44:47], s61 offen offset:32
    buffer_load_dwordx4 v[184:187], v12, s[44:47], s61 offen offset:64
    buffer_load_dwordx4 v[188:191], v12, s[44:47], s61 offen offset:96
    buffer_load_dwordx4 v[192:195], v12, s[44:47], s61 offen offset:128
    buffer_load_dwordx4 v[196:199], v12, s[44:47], s61 offen offset:160
    buffer_load_dwordx4 v[200:203], v12, s[44:47], s61 offen offset:192
    buffer_load_dwordx4 v[204:207], v12, s[44:47], s61 offen offset:224
    s_waitcnt vmcnt(0)
    v_mfma_f32_32x32x16_bf16 v[112:127], v[176:179], v[80:83], 0
    v_mfma_f32_32x32x16_bf16 v[112:127], v[180:183], v[84:87], v[112:127]
    v_mfma_f32_32x32x16_bf16 v[112:127], v[184:187], v[88:91], v[112:127]
    v_mfma_f32_32x32x16_bf16 v[112:127], v[188:191], v[92:95], v[112:127]
    v_mfma_f32_32x32x16_bf16 v[112:127], v[192:195], v[96:99], v[112:127]
    v_mfma_f32_32x32x16_bf16 v[112:127], v[196:199], v[100:103], v[112:127]
    v_mfma_f32_32x32x16_bf16 v[112:127], v[200:203], v[104:107], v[112:127]
    v_mfma_f32_32x32x16_bf16 v[112:127], v[204:207], v[108:111], v[112:127]
    s_nop 11
    v_max3_f32 v13, v13, v112, v113
    v_max3_f32 v13, v13, v114, v115
    v_max3_f32 v13, v13, v116, v117
    v_max3_f32 v13, v13, v118, v119
    v_max3_f32 v13, v13, v120, v121
    v_max3_f32 v13, v13, v122, v123
    v_max3_f32 v13, v13, v124, v125
    v_max3_f32 v13, v13, v126, v127
    s_add_u32 s61, s61, 8192
    s_cmp_lt_u32 s61, 131072
    s_cbranch_scc1 K2_SLOW_L1
    v_mov_b32 v15, v13
    s_nop 1
    v_permlane32_swap_b32 v15, v13
    v_max_f32 v13, v15, v13
    v_sub_f32 v144, 0, v13
    v_sub_f32 v145, 0, v13
    v_sub_f32 v146, 0, v13
    v_sub_f32 v147, 0, v13
    v_sub_f32 v148, 0, v13
    v_sub_f32 v149, 0, v13
    v_sub_f32 v150, 0, v13
    v_sub_f32 v151, 0, v13
    v_sub_f32 v152, 0, v13
    v_sub_f32 v153, 0, v13
    v_sub_f32 v154, 0, v13
    v_sub_f32 v155, 0, v13
    v_sub_f32 v156, 0, v13
    v_sub_f32 v157, 0, v13
    v_sub_f32 v158, 0, v13
    v_sub_f32 v159, 0, v13
    v_mov_b32 v16, 0
    v_mov_b32 v17, 0
    v_mov_b32 v18, 0
    v_mov_b32 v19, 0
    v_mov_b32 v20, 0
    v_mov_b32 v21, 0
    v_mov_b32 v22, 0
    v_mov_b32 v23, 0
    v_mov_b32 v24, 0
    v_mov_b32 v25, 0
    v_mov_b32 v26, 0
    v_mov_b32 v27, 0
    v_mov_b32 v28, 0
    v_mov_b32 v29, 0
    v_mov_b32 v30, 0
    v_mov_b32 v31, 0
    v_mov_b32 v32, 0
    v_mov_b32 v33, 0
    v_mov_b32 v34, 0
    v_mov_b32 v35, 0
    v_mov_b32 v36, 0
    v_mov_b32 v37, 0
    v_mov_b32 v38, 0
    v_mov_b32 v39, 0
    v_mov_b32 v40, 0
    v_mov_b32 v41, 0
    v_mov_b32 v42, 0
    v_mov_b32 v43, 0
    v_mov_b32 v44, 0
    v_mov_b32 v45, 0
    v_mov_b32 v46, 0
    v_mov_b32 v47, 0
    v_mov_b32 v48, 0
    v_mov_b32 v49, 0
    v_mov_b32 v50, 0
    v_mov_b32 v51, 0
    v_mov_b32 v52, 0
    v_mov_b32 v53, 0
    v_mov_b32 v54, 0
    v_mov_b32 v55, 0
    v_mov_b32 v56, 0
    v_mov_b32 v57, 0
    v_mov_b32 v58, 0
    v_mov_b32 v59, 0
    v_mov_b32 v60, 0
    v_mov_b32 v61, 0
    v_mov_b32 v62, 0
    v_mov_b32 v63, 0
    v_mov_b32 v64, 0
    v_mov_b32 v65, 0
    v_mov_b32 v66, 0
    v_mov_b32 v67, 0
    v_mov_b32 v68, 0
    v_mov_b32 v69, 0
    v_mov_b32 v70, 0
    v_mov_b32 v71, 0
    v_mov_b32 v72, 0
    v_mov_b32 v73, 0
    v_mov_b32 v74, 0
    v_mov_b32 v75, 0
    v_mov_b32 v76, 0
    v_mov_b32 v77, 0
    v_mov_b32 v78, 0
    v_mov_b32 v79, 0
    v_mov_b32 v8, 0
    s_mov_b32 s61, 0
K2_SLOW_L2:
    buffer_load_dwordx4 v[176:179], v12, s[44:47], s61 offen offset:0
    buffer_load_dwordx4 v[180:183], v12, s[44:47], s61 offen offset:32
    buffer_load_dwordx4 v[184:187], v12, s[44:47], s61 offen offset:64
    buffer_load_dwordx4 v[188:191], v12, s[44:47], s61 offen offset:96
    buffer_load_dwordx4 v[192:195], v12, s[44:47], s61 offen offset:128
    buffer_load_dwordx4 v[196:199], v12, s[44:47], s61 offen offset:160
    buffer_load_dwordx4 v[200:203], v12, s[44:47], s61 offen offset:192
    buffer_load_dwordx4 v[204:207], v12, s[44:47], s61 offen offset:224
    s_waitcnt vmcnt(0)
    v_mfma_f32_32x32x16_bf16 v[112:127], v[176:179], v[80:83], v[144:159]
    v_mfma_f32_32x32x16_bf16 v[112:127], v[180:183], v[84:87], v[112:127]
    v_mfma_f32_32x32x16_bf16 v[112:127], v[184:187], v[88:91], v[112:127]
    v_mfma_f32_32x32x16_bf16 v[112:127], v[188:191], v[92:95], v[112:127]
    v_mfma_f32_32x32x16_bf16 v[112:127], v[192:195], v[96:99], v[112:127]
    v_mfma_f32_32x32x16_bf16 v[112:127], v[196:199], v[100:103], v[112:127]
    v_mfma_f32_32x32x16_bf16 v[112:127], v[200:203], v[104:107], v[112:127]
    v_mfma_f32_32x32x16_bf16 v[112:127], v[204:207], v[108:111], v[112:127]
    s_nop 11
    v_exp_f32 v112, v112
    v_exp_f32 v113, v113
    v_exp_f32 v114, v114
    v_exp_f32 v115, v115
    v_exp_f32 v116, v116
    v_exp_f32 v117, v117
    v_exp_f32 v118, v118
    v_exp_f32 v119, v119
    v_exp_f32 v120, v120
    v_exp_f32 v121, v121
    v_exp_f32 v122, v122
    v_exp_f32 v123, v123
    v_exp_f32 v124, v124
    v_exp_f32 v125, v125
    v_exp_f32 v126, v126
    v_exp_f32 v127, v127
    v_add_f32 v8, v8, v112
    v_add_f32 v8, v8, v113
    v_add_f32 v8, v8, v114
    v_add_f32 v8, v8, v115
    v_add_f32 v8, v8, v116
    v_add_f32 v8, v8, v117
    v_add_f32 v8, v8, v118
    v_add_f32 v8, v8, v119
    v_add_f32 v8, v8, v120
    v_add_f32 v8, v8, v121
    v_add_f32 v8, v8, v122
    v_add_f32 v8, v8, v123
    v_add_f32 v8, v8, v124
    v_add_f32 v8, v8, v125
    v_add_f32 v8, v8, v126
    v_add_f32 v8, v8, v127
    v_cvt_pk_bf16_f32 v160, v112, v113
    v_cvt_pk_bf16_f32 v161, v114, v115
    v_cvt_pk_bf16_f32 v162, v116, v117
    v_cvt_pk_bf16_f32 v163, v118, v119
    v_cvt_pk_bf16_f32 v164, v120, v121
    v_cvt_pk_bf16_f32 v165, v122, v123
    v_cvt_pk_bf16_f32 v166, v124, v125
    v_cvt_pk_bf16_f32 v167, v126, v127
    s_add_u32 s62, s61, 0
    buffer_load_ushort v128, v14, s[48:51], s62 offen offset:0
    buffer_load_ushort v129, v14, s[48:51], s62 offen offset:256
    buffer_load_ushort v130, v14, s[48:51], s62 offen offset:512
    buffer_load_ushort v131, v14, s[48:51], s62 offen offset:768
    buffer_load_ushort v132, v14, s[48:51], s62 offen offset:2048
    buffer_load_ushort v133, v14, s[48:51], s62 offen offset:2304
    buffer_load_ushort v134, v14, s[48:51], s62 offen offset:2560
    buffer_load_ushort v135, v14, s[48:51], s62 offen offset:2816
    s_waitcnt vmcnt(0)
    v_lshl_or_b32 v176, v129, 16, v128
    v_lshl_or_b32 v177, v131, 16, v130
    v_lshl_or_b32 v178, v133, 16, v132
    v_lshl_or_b32 v179, v135, 16, v134
    s_nop 1
    v_mfma_f32_32x32x16_bf16 v[16:31], v[176:179], v[160:163], v[16:31]
    buffer_load_ushort v128, v14, s[48:51], s62 offen offset:64
    buffer_load_ushort v129, v14, s[48:51], s62 offen offset:320
    buffer_load_ushort v130, v14, s[48:51], s62 offen offset:576
    buffer_load_ushort v131, v14, s[48:51], s62 offen offset:832
    buffer_load_ushort v132, v14, s[48:51], s62 offen offset:2112
    buffer_load_ushort v133, v14, s[48:51], s62 offen offset:2368
    buffer_load_ushort v134, v14, s[48:51], s62 offen offset:2624
    buffer_load_ushort v135, v14, s[48:51], s62 offen offset:2880
    s_waitcnt vmcnt(0)
    v_lshl_or_b32 v180, v129, 16, v128
    v_lshl_or_b32 v181, v131, 16, v130
    v_lshl_or_b32 v182, v133, 16, v132
    v_lshl_or_b32 v183, v135, 16, v134
    s_nop 1
    v_mfma_f32_32x32x16_bf16 v[32:47], v[180:183], v[160:163], v[32:47]
    buffer_load_ushort v128, v14, s[48:51], s62 offen offset:128
    buffer_load_ushort v129, v14, s[48:51], s62 offen offset:384
    buffer_load_ushort v130, v14, s[48:51], s62 offen offset:640
    buffer_load_ushort v131, v14, s[48:51], s62 offen offset:896
    buffer_load_ushort v132, v14, s[48:51], s62 offen offset:2176
    buffer_load_ushort v133, v14, s[48:51], s62 offen offset:2432
    buffer_load_ushort v134, v14, s[48:51], s62 offen offset:2688
    buffer_load_ushort v135, v14, s[48:51], s62 offen offset:2944
    s_waitcnt vmcnt(0)
    v_lshl_or_b32 v184, v129, 16, v128
    v_lshl_or_b32 v185, v131, 16, v130
    v_lshl_or_b32 v186, v133, 16, v132
    v_lshl_or_b32 v187, v135, 16, v134
    s_nop 1
    v_mfma_f32_32x32x16_bf16 v[48:63], v[184:187], v[160:163], v[48:63]
    buffer_load_ushort v128, v14, s[48:51], s62 offen offset:192
    buffer_load_ushort v129, v14, s[48:51], s62 offen offset:448
    buffer_load_ushort v130, v14, s[48:51], s62 offen offset:704
    buffer_load_ushort v131, v14, s[48:51], s62 offen offset:960
    buffer_load_ushort v132, v14, s[48:51], s62 offen offset:2240
    buffer_load_ushort v133, v14, s[48:51], s62 offen offset:2496
    buffer_load_ushort v134, v14, s[48:51], s62 offen offset:2752
    buffer_load_ushort v135, v14, s[48:51], s62 offen offset:3008
    s_waitcnt vmcnt(0)
    v_lshl_or_b32 v188, v129, 16, v128
    v_lshl_or_b32 v189, v131, 16, v130
    v_lshl_or_b32 v190, v133, 16, v132
    v_lshl_or_b32 v191, v135, 16, v134
    s_nop 1
    v_mfma_f32_32x32x16_bf16 v[64:79], v[188:191], v[160:163], v[64:79]
    s_nop 7
    s_add_u32 s62, s61, 4096
    buffer_load_ushort v128, v14, s[48:51], s62 offen offset:0
    buffer_load_ushort v129, v14, s[48:51], s62 offen offset:256
    buffer_load_ushort v130, v14, s[48:51], s62 offen offset:512
    buffer_load_ushort v131, v14, s[48:51], s62 offen offset:768
    buffer_load_ushort v132, v14, s[48:51], s62 offen offset:2048
    buffer_load_ushort v133, v14, s[48:51], s62 offen offset:2304
    buffer_load_ushort v134, v14, s[48:51], s62 offen offset:2560
    buffer_load_ushort v135, v14, s[48:51], s62 offen offset:2816
    s_waitcnt vmcnt(0)
    v_lshl_or_b32 v176, v129, 16, v128
    v_lshl_or_b32 v177, v131, 16, v130
    v_lshl_or_b32 v178, v133, 16, v132
    v_lshl_or_b32 v179, v135, 16, v134
    s_nop 1
    v_mfma_f32_32x32x16_bf16 v[16:31], v[176:179], v[164:167], v[16:31]
    buffer_load_ushort v128, v14, s[48:51], s62 offen offset:64
    buffer_load_ushort v129, v14, s[48:51], s62 offen offset:320
    buffer_load_ushort v130, v14, s[48:51], s62 offen offset:576
    buffer_load_ushort v131, v14, s[48:51], s62 offen offset:832
    buffer_load_ushort v132, v14, s[48:51], s62 offen offset:2112
    buffer_load_ushort v133, v14, s[48:51], s62 offen offset:2368
    buffer_load_ushort v134, v14, s[48:51], s62 offen offset:2624
    buffer_load_ushort v135, v14, s[48:51], s62 offen offset:2880
    s_waitcnt vmcnt(0)
    v_lshl_or_b32 v180, v129, 16, v128
    v_lshl_or_b32 v181, v131, 16, v130
    v_lshl_or_b32 v182, v133, 16, v132
    v_lshl_or_b32 v183, v135, 16, v134
    s_nop 1
    v_mfma_f32_32x32x16_bf16 v[32:47], v[180:183], v[164:167], v[32:47]
    buffer_load_ushort v128, v14, s[48:51], s62 offen offset:128
    buffer_load_ushort v129, v14, s[48:51], s62 offen offset:384
    buffer_load_ushort v130, v14, s[48:51], s62 offen offset:640
    buffer_load_ushort v131, v14, s[48:51], s62 offen offset:896
    buffer_load_ushort v132, v14, s[48:51], s62 offen offset:2176
    buffer_load_ushort v133, v14, s[48:51], s62 offen offset:2432
    buffer_load_ushort v134, v14, s[48:51], s62 offen offset:2688
    buffer_load_ushort v135, v14, s[48:51], s62 offen offset:2944
    s_waitcnt vmcnt(0)
    v_lshl_or_b32 v184, v129, 16, v128
    v_lshl_or_b32 v185, v131, 16, v130
    v_lshl_or_b32 v186, v133, 16, v132
    v_lshl_or_b32 v187, v135, 16, v134
    s_nop 1
    v_mfma_f32_32x32x16_bf16 v[48:63], v[184:187], v[164:167], v[48:63]
    buffer_load_ushort v128, v14, s[48:51], s62 offen offset:192
    buffer_load_ushort v129, v14, s[48:51], s62 offen offset:448
    buffer_load_ushort v130, v14, s[48:51], s62 offen offset:704
    buffer_load_ushort v131, v14, s[48:51], s62 offen offset:960
    buffer_load_ushort v132, v14, s[48:51], s62 offen offset:2240
    buffer_load_ushort v133, v14, s[48:51], s62 offen offset:2496
    buffer_load_ushort v134, v14, s[48:51], s62 offen offset:2752
    buffer_load_ushort v135, v14, s[48:51], s62 offen offset:3008
    s_waitcnt vmcnt(0)
    v_lshl_or_b32 v188, v129, 16, v128
    v_lshl_or_b32 v189, v131, 16, v130
    v_lshl_or_b32 v190, v133, 16, v132
    v_lshl_or_b32 v191, v135, 16, v134
    s_nop 1
    v_mfma_f32_32x32x16_bf16 v[64:79], v[188:191], v[164:167], v[64:79]
    s_nop 7
    s_add_u32 s61, s61, 8192
    s_cmp_lt_u32 s61, 131072
    s_cbranch_scc1 K2_SLOW_L2
    v_mov_b32 v9, v8
    s_nop 1
    v_permlane32_swap_b32 v8, v9
    v_add_f32 v8, v8, v9
    v_rcp_f32 v9, v8
    s_nop 7
    s_branch K2_SLOW_RET
.section .rodata,"a"
.p2align 6
.amdhsa_kernel recurrent_scan__sliding_block_cached__moe_arch_mod__prompt_kernel
  .amdhsa_next_free_vgpr 256
  .amdhsa_next_free_sgpr 102
  .amdhsa_accum_offset 256
  .amdhsa_group_segment_fixed_size 0
  .amdhsa_kernarg_size 104
  .amdhsa_user_sgpr_count 2
  .amdhsa_user_sgpr_kernarg_segment_ptr 1
  .amdhsa_system_sgpr_workgroup_id_x 1
  .amdhsa_float_denorm_mode_32 3
  .amdhsa_float_denorm_mode_16_64 3
.end_amdhsa_kernel
```
